```python
import torch

def _softmax(x, axis=-1):
    return torch.softmax(x, dim=axis)
def _gelu(x):
    return torch.nn.functional.gelu(x, approximate="tanh")
def _silu(x):
    return torch.nn.functional.silu(x)
def _sigmoid(x):
    return torch.sigmoid(x)
def _layernorm(x, axis=-1, eps=1e-5):
    m = x.mean(dim=axis, keepdim=True)
    v = x.var(dim=axis, keepdim=True, unbiased=False)
    return (x - m) / torch.sqrt(v + eps)
def _scatter_add(tgt, idx, src, axis=0):
    return tgt.clone().index_add_(axis, idx, src)
def _segment_sum(src, seg, n):
    out = torch.zeros((n,) + src.shape[1:], dtype=src.dtype)
    return out.index_add_(0, seg, src)
def _pad(x, pw):
    flat = tuple(v for pair in reversed(pw) for v in pair)
    return torch.nn.functional.pad(x, flat)

kernel_name = 'standalone__kv_cache_quant_int4_int2_kv_with_per_channel_or_per_token_scales__prompt'

def setup_inputs():

    _w = (lambda a: (lambda t: t.to(torch.bfloat16) if t.is_floating_point() else t)(torch.as_tensor(a)))
    B = 1
    Sq = 2048
    Skv = 2048
    Hq = 32
    Hkv = 8
    Dh = 128
    bits = 8
    G = 64
    if G <= 0 or G >= Skv:
        G = max(1, Skv // 2)
    Skv = (Skv // G) * G
    ngk = Skv // G
    qmax = (1 << bits) - 1
    return {
        "q": _w((lambda *s: torch.randn(*s, dtype=torch.bfloat16) * 0.2)(B, Hq, Sq, Dh)),
        "qk": _w(torch.randint(0, qmax + 1, (B, Hkv, Skv, Dh)).to(torch.int32)),
        "qv": _w(torch.randint(0, qmax + 1, (B, Hkv, Skv, Dh)).to(torch.int32)),
        "k_scales": _w(torch.abs((lambda *s: torch.randn(*s, dtype=torch.bfloat16) * 0.2)(B, Hkv, ngk, Dh)) * 0.05 + 0.02),
        "k_zeros": _w((lambda *s: torch.randn(*s, dtype=torch.bfloat16) * 0.2)(B, Hkv, ngk, Dh) + float(qmax) / 2.0),
        "v_scales": _w(torch.abs((lambda *s: torch.randn(*s, dtype=torch.bfloat16) * 0.05)(B, Hkv, Skv, 1)) * 0.05 + 0.02),
        "v_zeros": _w((lambda *s: torch.randn(*s, dtype=torch.bfloat16) * 0.05)(B, Hkv, Skv, 1) + float(qmax) / 2.0),
    }

def reference(q, qk, qv, k_scales, k_zeros, v_scales, v_zeros):
    B, Hq, Sq, Dh = q.shape
    Hkv, Skv = qk.shape[1], qk.shape[2]
    ngk = k_scales.shape[2]
    G = Skv // ngk
    ks = (lambda x, n, axis: torch.repeat_interleave(x, n, dim=axis))(k_scales, G, axis=2)
    kz = (lambda x, n, axis: torch.repeat_interleave(x, n, dim=axis))(k_zeros, G, axis=2)
    k = ((lambda x, dt: x.to(dt))(qk, q.dtype) - kz) * ks
    v = ((lambda x, dt: x.to(dt))(qv, q.dtype) - v_zeros) * v_scales
    rep = Hq // Hkv
    if rep > 1:
        k = (lambda x, n, axis: torch.repeat_interleave(x, n, dim=axis))(k, rep, axis=1)
        v = (lambda x, n, axis: torch.repeat_interleave(x, n, dim=axis))(v, rep, axis=1)
    scale = float(Dh) ** -0.5
    logits = torch.einsum("bhqd,bhkd->bhqk", q, k) * scale
    p = _softmax(logits, axis=-1)
    o = torch.einsum("bhqk,bhkd->bhqd", p, v)
    return o
```

```asm
; @launch grid=(256,1,1) block=(256,1,1) lds=139264
.amdgcn_target "amdgcn-amd-amdhsa--gfx950"
.text
.p2align 8
.globl standalone__kv_cache_quant_int4_int2_kv_with_per_channel_or_per_token_scales__prompt_kernel
.type standalone__kv_cache_quant_int4_int2_kv_with_per_channel_or_per_token_scales__prompt_kernel,@function
standalone__kv_cache_quant_int4_int2_kv_with_per_channel_or_per_token_scales__prompt_kernel:
    s_cmp_ge_u32 s2, 256
    s_cbranch_scc1 L_done
    s_load_dwordx4 s[92:95], s[0:1], 0
    s_load_dwordx4 s[96:99], s[0:1], 16
    s_load_dwordx4 s[24:27], s[0:1], 32
    s_load_dwordx4 s[28:31], s[0:1], 48
    s_load_dwordx4 s[88:91], s[0:1], 64
    v_lshrrev_b32 v170, 6, v0
    v_and_b32 v171, 63, v0
    v_readfirstlane_b32 s32, v170
    s_and_b32 s33, s2, 7
    s_lshr_b32 s34, s2, 3
    s_mov_b32 s72, s34
    s_mov_b32 s73, s32
    v_and_b32 v6, 15, v171
    v_lshrrev_b32 v7, 4, v171
    v_lshlrev_b32 v240, 9, v6
    v_lshl_add_u32 v240, v7, 5, v240
    v_lshlrev_b32 v241, 4, v7
    v_and_b32 v8, 31, v171
    v_lshrrev_b32 v9, 5, v171
    v_lshlrev_b32 v242, 11, v9
    v_lshl_add_u32 v242, v8, 4, v242
    v_lshlrev_b32 v243, 3, v9
    s_waitcnt lgkmcnt(0)
    s_mov_b32 s44, s94
    s_and_b32 s45, s95, 0xffff
    s_mov_b32 s46, 0x800000
    s_mov_b32 s47, 0x00020000
    s_mov_b32 s52, s98
    s_and_b32 s53, s99, 0xffff
    s_mov_b32 s54, 0x10000
    s_mov_b32 s55, 0x00020000
    s_mov_b32 s56, s24
    s_and_b32 s57, s25, 0xffff
    s_mov_b32 s58, 0x10000
    s_mov_b32 s59, 0x00020000
    s_mov_b32 s48, s96
    s_and_b32 s49, s97, 0xffff
    s_mov_b32 s50, 0x800000
    s_mov_b32 s51, 0x00020000
    s_mov_b32 s60, s26
    s_and_b32 s61, s27, 0xffff
    s_mov_b32 s62, 0x8000
    s_mov_b32 s63, 0x00020000
    s_mov_b32 s64, s28
    s_and_b32 s65, s29, 0xffff
    s_mov_b32 s66, 0x8000
    s_mov_b32 s67, 0x00020000
    s_lshl_b32 s75, s33, 5
    s_add_u32 s75, s75, s72
    s_lshl_b32 s76, s75, 8
    s_lshl_b32 s77, s75, 6
    s_lshl_b32 s74, s73, 4
    s_add_u32 s74, s74, s77
    s_lshl_b32 s74, s74, 9
    buffer_load_dwordx4 v[16:19], v240, s[44:47], s74 offen offset:0
    buffer_load_dwordx4 v[20:23], v240, s[44:47], s74 offen offset:16
    buffer_load_dwordx4 v[24:27], v240, s[44:47], s74 offen offset:128
    buffer_load_dwordx4 v[28:31], v240, s[44:47], s74 offen offset:144
    buffer_load_dwordx4 v[32:35], v240, s[44:47], s74 offen offset:256
    buffer_load_dwordx4 v[36:39], v240, s[44:47], s74 offen offset:272
    buffer_load_dwordx4 v[40:43], v240, s[44:47], s74 offen offset:384
    buffer_load_dwordx4 v[44:47], v240, s[44:47], s74 offen offset:400
    buffer_load_dwordx4 v[48:51], v241, s[52:55], s76 offen offset:0
    buffer_load_dwordx4 v[64:67], v241, s[56:59], s76 offen offset:0
    buffer_load_dwordx4 v[52:55], v241, s[52:55], s76 offen offset:64
    buffer_load_dwordx4 v[68:71], v241, s[56:59], s76 offen offset:64
    buffer_load_dwordx4 v[56:59], v241, s[52:55], s76 offen offset:128
    buffer_load_dwordx4 v[72:75], v241, s[56:59], s76 offen offset:128
    buffer_load_dwordx4 v[60:63], v241, s[52:55], s76 offen offset:192
    buffer_load_dwordx4 v[76:79], v241, s[56:59], s76 offen offset:192
    s_lshr_b32 s78, s73, 1
    s_and_b32 s79, s73, 1
    s_lshl_b32 s75, s78, 5
    s_add_u32 s77, s77, s75
    s_lshl_b32 s75, s79, 3
    s_add_u32 s77, s77, s75
    s_lshl_b32 s80, s77, 1
    s_lshl_b32 s77, s77, 9
    s_add_u32 s81, s77, 8192
    buffer_load_dwordx4 v[128:131], v242, s[48:51], s77 offen offset:0
    buffer_load_dwordx4 v[132:135], v242, s[48:51], s77 offen offset:512
    buffer_load_dwordx4 v[136:139], v242, s[48:51], s77 offen offset:1024
    buffer_load_dwordx4 v[140:143], v242, s[48:51], s77 offen offset:1536
    buffer_load_dwordx4 v[144:147], v242, s[48:51], s81 offen offset:0
    buffer_load_dwordx4 v[148:151], v242, s[48:51], s81 offen offset:512
    buffer_load_dwordx4 v[152:155], v242, s[48:51], s81 offen offset:1024
    buffer_load_dwordx4 v[156:159], v242, s[48:51], s81 offen offset:1536
    buffer_load_dwordx2 v[192:193], v243, s[60:63], s80 offen
    buffer_load_dwordx2 v[194:195], v243, s[60:63], s80 offen offset:32
    buffer_load_dwordx2 v[196:197], v243, s[64:67], s80 offen
    buffer_load_dwordx2 v[198:199], v243, s[64:67], s80 offen offset:32
    s_mov_b32 s4, s90
    s_and_b32 s5, s91, 0xffff
    s_mov_b32 s6, 0x10000000
    s_mov_b32 s7, 0x00020000
    s_mov_b32 s8, s92
    s_and_b32 s9, s93, 0xffff
    s_mov_b32 s10, 0x1000000
    s_mov_b32 s11, 0x00020000
    s_mov_b32 s12, s30
    s_and_b32 s13, s31, 0xffff
    s_mov_b32 s14, 0x1000000
    s_mov_b32 s15, 0x00020000
    s_mov_b32 s68, s88
    s_and_b32 s69, s89, 0xffff
    s_mov_b32 s70, 0x100
    s_mov_b32 s71, 0x00020000
    v_lshrrev_b32 v10, 3, v8
    v_lshlrev_b32 v244, 12, v10
    v_and_b32 v10, 1, v8
    v_lshl_add_u32 v244, v10, 11, v244
    v_bfe_u32 v10, v8, 1, 2
    v_lshl_add_u32 v244, v10, 6, v244
    v_lshl_add_u32 v244, v9, 8, v244
    v_lshlrev_b32 v247, 11, v9
    v_lshl_add_u32 v247, v8, 4, v247
    s_lshl_b32 s75, s78, 10
    s_lshl_b32 s76, s79, 9
    s_add_u32 s75, s75, s76
    s_add_u32 s75, s75, 40960
    v_add_u32 v244, s75, v244
    v_add_u32 v191, s75, v247
    v_lshlrev_b32 v164, 4, v171
    s_and_b32 s35, s34, 3
    s_lshl_b32 s36, s33, 2
    s_add_u32 s35, s35, s36
    s_lshr_b32 s36, s34, 2
    s_lshl_b32 s35, s35, 11
    s_lshl_b32 s36, s36, 8
    s_add_u32 s35, s35, s36
    s_lshl_b32 s36, s32, 6
    s_add_u32 s35, s35, s36
    s_lshl_b32 s35, s35, 8
    s_add_u32 s36, s35, 0x1000
    s_add_u32 s37, s35, 0x2000
    s_add_u32 s38, s35, 0x3000
    s_lshl_b32 s22, s33, 21
    s_lshl_b32 s23, s32, 13
    s_mov_b32 s84, 0xffff0000
    s_mov_b32 s86, 0x3e0293ee
    s_mov_b32 s87, s86
    s_mov_b32 s24, 0
    s_mov_b32 s92, 0
    s_lshl_b32 s82, s72, 15
    s_add_u32 s83, s82, 0x8000
    s_and_b32 s83, s83, 0xfffff
    s_add_u32 s83, s83, 8192
    s_lshl_b32 s75, s78, 10
    s_add_u32 s83, s83, s75
    s_lshl_b32 s75, s79, 9
    s_add_u32 s83, s83, s75
    s_add_u32 s83, s83, s22
    s_lshl_b32 s75, s73, 12
    s_add_u32 s82, s82, s75
    s_sub_u32 s82, s82, 8192
    s_and_b32 s82, s82, 0xfffff
    s_add_u32 s82, s82, s22
    v_lshlrev_b32 v180, 8, v6
    v_lshl_add_u32 v180, v7, 4, v180
    buffer_load_dwordx4 a[128:131], v180, s[8:11], s35 offen offset:0
    buffer_load_dwordx4 a[132:135], v180, s[8:11], s35 offen offset:64
    buffer_load_dwordx4 a[136:139], v180, s[8:11], s35 offen offset:128
    buffer_load_dwordx4 a[140:143], v180, s[8:11], s35 offen offset:192
    buffer_load_dwordx4 a[144:147], v180, s[8:11], s36 offen offset:0
    buffer_load_dwordx4 a[148:151], v180, s[8:11], s36 offen offset:64
    buffer_load_dwordx4 a[152:155], v180, s[8:11], s36 offen offset:128
    buffer_load_dwordx4 a[156:159], v180, s[8:11], s36 offen offset:192
    buffer_load_dwordx4 a[160:163], v180, s[8:11], s37 offen offset:0
    buffer_load_dwordx4 a[164:167], v180, s[8:11], s37 offen offset:64
    buffer_load_dwordx4 a[168:171], v180, s[8:11], s37 offen offset:128
    buffer_load_dwordx4 a[172:175], v180, s[8:11], s37 offen offset:192
    buffer_load_dwordx4 a[176:179], v180, s[8:11], s38 offen offset:0
    buffer_load_dwordx4 a[180:183], v180, s[8:11], s38 offen offset:64
    buffer_load_dwordx4 a[184:187], v180, s[8:11], s38 offen offset:128
    buffer_load_dwordx4 a[188:191], v180, s[8:11], s38 offen offset:192
    s_add_u32 s39, s22, s23
    v_add_u32 v168, s39, v164
    v_add_u32 v169, 0x1000, v168
    s_lshl_b32 s39, s33, 5
    v_add_u32 v190, s39, v8
    v_subrev_u32 v246, s34, v8
    v_add_u32 v246, -1, v246
    v_and_b32 v246, 28, v246
    s_xor_b32 s75, s23, 0x4000
    s_lshr_b32 s75, s75, 1
    v_add_u32 v245, s75, v164
    v_mov_b32 v165, v164
    v_mov_b32 v12, 0
    v_mov_b32 v13, 0
    v_mov_b32 v14, 0
    v_mov_b32 v15, 0
    v_mov_b32 v170, 0x3f803f80
    v_accvgpr_write_b32 a240, v170
    v_accvgpr_write_b32 a241, v170
    v_accvgpr_write_b32 a242, v170
    v_accvgpr_write_b32 a243, v170
    v_mfma_f32_32x32x16_bf16 a[0:15], v[12:15], v[12:15], 0
    v_mfma_f32_32x32x16_bf16 a[16:31], v[12:15], v[12:15], 0
    v_mfma_f32_32x32x16_bf16 a[32:47], v[12:15], v[12:15], 0
    v_mfma_f32_32x32x16_bf16 a[48:63], v[12:15], v[12:15], 0
    v_mfma_f32_32x32x16_bf16 a[64:79], v[12:15], v[12:15], 0
    v_mfma_f32_32x32x16_bf16 a[80:95], v[12:15], v[12:15], 0
    v_mfma_f32_32x32x16_bf16 a[96:111], v[12:15], v[12:15], 0
    v_mfma_f32_32x32x16_bf16 a[112:127], v[12:15], v[12:15], 0
    v_mfma_f32_32x32x16_bf16 a[224:239], v[12:15], v[12:15], 0
    s_waitcnt vmcnt(28)
    s_mov_b32 s88, 0
    s_mov_b32 s89, 0
L_dk0:
    s_set_gpr_idx_on s88, gpr_idx(SRC0)
    s_nop 1
    v_cvt_f32_i32 v80, v16
    v_cvt_f32_i32 v81, v17
    v_cvt_f32_i32 v82, v18
    v_cvt_f32_i32 v83, v19
    v_cvt_f32_i32 v84, v20
    v_cvt_f32_i32 v85, v21
    v_cvt_f32_i32 v86, v22
    v_cvt_f32_i32 v87, v23
    s_set_gpr_idx_idx s89
    s_set_gpr_idx_mode gpr_idx(SRC1)
    s_nop 1
    v_lshlrev_b32 v88, 16, v64
    v_and_b32 v89, s84, v64
    v_lshlrev_b32 v96, 16, v48
    v_and_b32 v97, s84, v48
    v_lshlrev_b32 v90, 16, v65
    v_and_b32 v91, s84, v65
    v_lshlrev_b32 v98, 16, v49
    v_and_b32 v99, s84, v49
    v_lshlrev_b32 v92, 16, v66
    v_and_b32 v93, s84, v66
    v_lshlrev_b32 v100, 16, v50
    v_and_b32 v101, s84, v50
    v_lshlrev_b32 v94, 16, v67
    v_and_b32 v95, s84, v67
    v_lshlrev_b32 v102, 16, v51
    v_and_b32 v103, s84, v51
    s_set_gpr_idx_off
    s_nop 1
    v_pk_add_f32 v[80:81], v[80:81], v[88:89] neg_lo:[0,1] neg_hi:[0,1]
    v_pk_add_f32 v[82:83], v[82:83], v[90:91] neg_lo:[0,1] neg_hi:[0,1]
    v_pk_add_f32 v[84:85], v[84:85], v[92:93] neg_lo:[0,1] neg_hi:[0,1]
    v_pk_add_f32 v[86:87], v[86:87], v[94:95] neg_lo:[0,1] neg_hi:[0,1]
    v_cvt_pk_bf16_f32 v104, v80, v81
    v_cvt_pk_bf16_f32 v105, v82, v83
    v_cvt_pk_bf16_f32 v106, v84, v85
    v_cvt_pk_bf16_f32 v107, v86, v87
    v_lshlrev_b32 v80, 16, v104
    v_and_b32 v81, s84, v104
    v_lshlrev_b32 v82, 16, v105
    v_and_b32 v83, s84, v105
    v_lshlrev_b32 v84, 16, v106
    v_and_b32 v85, s84, v106
    v_lshlrev_b32 v86, 16, v107
    v_and_b32 v87, s84, v107
    v_pk_mul_f32 v[80:81], v[80:81], v[96:97]
    v_pk_mul_f32 v[82:83], v[82:83], v[98:99]
    v_pk_mul_f32 v[84:85], v[84:85], v[100:101]
    v_pk_mul_f32 v[86:87], v[86:87], v[102:103]
    v_cvt_pk_bf16_f32 v104, v80, v81
    v_cvt_pk_bf16_f32 v105, v82, v83
    v_cvt_pk_bf16_f32 v106, v84, v85
    v_cvt_pk_bf16_f32 v107, v86, v87
    v_lshlrev_b32 v80, 16, v104
    v_and_b32 v81, s84, v104
    v_lshlrev_b32 v82, 16, v105
    v_and_b32 v83, s84, v105
    v_lshlrev_b32 v84, 16, v106
    v_and_b32 v85, s84, v106
    v_lshlrev_b32 v86, 16, v107
    v_and_b32 v87, s84, v107
    v_pk_mul_f32 v[80:81], v[80:81], s[86:87]
    v_pk_mul_f32 v[82:83], v[82:83], s[86:87]
    v_pk_mul_f32 v[84:85], v[84:85], s[86:87]
    v_pk_mul_f32 v[86:87], v[86:87], s[86:87]
    v_cvt_pk_bf16_f32 v108, v80, v81
    v_cvt_pk_bf16_f32 v109, v82, v83
    v_cvt_pk_bf16_f32 v110, v84, v85
    v_cvt_pk_bf16_f32 v111, v86, v87
    buffer_store_dwordx4 v[108:111], v164, s[4:7], s82 offen sc1
    ds_write_b128 v245, v[108:111]
    v_add_u32 v245, 0x400, v245
    s_add_u32 s82, s82, 0x400
    s_add_u32 s88, s88, 8
    s_add_u32 s89, s89, 4
    s_cmp_lt_u32 s89, 16
    s_cbranch_scc1 L_dk0
    s_waitcnt vmcnt(20)
    v_lshlrev_b32 v96, 16, v192
    v_and_b32 v97, s84, v192
    v_lshlrev_b32 v88, 16, v196
    v_and_b32 v89, s84, v196
    v_lshlrev_b32 v98, 16, v193
    v_and_b32 v99, s84, v193
    v_lshlrev_b32 v90, 16, v197
    v_and_b32 v91, s84, v197
    v_lshlrev_b32 v100, 16, v194
    v_and_b32 v101, s84, v194
    v_lshlrev_b32 v92, 16, v198
    v_and_b32 v93, s84, v198
    v_lshlrev_b32 v102, 16, v195
    v_and_b32 v103, s84, v195
    v_lshlrev_b32 v94, 16, v199
    v_and_b32 v95, s84, v199
    s_mov_b32 s89, 0
L_dv0:
    s_set_gpr_idx_on s89, gpr_idx(SRC0)
    s_nop 1
    v_cvt_f32_i32 v80, v128
    v_cvt_f32_i32 v81, v132
    v_cvt_f32_i32 v82, v136
    v_cvt_f32_i32 v83, v140
    v_cvt_f32_i32 v84, v144
    v_cvt_f32_i32 v85, v148
    v_cvt_f32_i32 v86, v152
    v_cvt_f32_i32 v87, v156
    s_set_gpr_idx_off
    s_nop 1
    v_pk_add_f32 v[80:81], v[80:81], v[88:89] neg_lo:[0,1] neg_hi:[0,1]
    v_pk_add_f32 v[82:83], v[82:83], v[90:91] neg_lo:[0,1] neg_hi:[0,1]
    v_pk_add_f32 v[84:85], v[84:85], v[92:93] neg_lo:[0,1] neg_hi:[0,1]
    v_pk_add_f32 v[86:87], v[86:87], v[94:95] neg_lo:[0,1] neg_hi:[0,1]
    v_cvt_pk_bf16_f32 v104, v80, v81
    v_cvt_pk_bf16_f32 v105, v82, v83
    v_cvt_pk_bf16_f32 v106, v84, v85
    v_cvt_pk_bf16_f32 v107, v86, v87
    v_lshlrev_b32 v80, 16, v104
    v_and_b32 v81, s84, v104
    v_lshlrev_b32 v82, 16, v105
    v_and_b32 v83, s84, v105
    v_lshlrev_b32 v84, 16, v106
    v_and_b32 v85, s84, v106
    v_lshlrev_b32 v86, 16, v107
    v_and_b32 v87, s84, v107
    v_pk_mul_f32 v[80:81], v[80:81], v[96:97]
    v_pk_mul_f32 v[82:83], v[82:83], v[98:99]
    v_pk_mul_f32 v[84:85], v[84:85], v[100:101]
    v_pk_mul_f32 v[86:87], v[86:87], v[102:103]
    v_cvt_pk_bf16_f32 v108, v80, v81
    v_cvt_pk_bf16_f32 v109, v82, v83
    v_cvt_pk_bf16_f32 v110, v84, v85
    v_cvt_pk_bf16_f32 v111, v86, v87
    ds_write_b128 v244, v[108:111]
    v_add_u32 v244, 16, v244
    s_add_u32 s89, s89, 1
    s_cmp_lt_u32 s89, 4
    s_cbranch_scc1 L_dv0
    v_add_u32 v244, -64, v244
    ds_read_b128 v[16:19], v191 offset:0
    ds_read_b128 v[20:23], v191 offset:4096
    ds_read_b128 v[24:27], v191 offset:8192
    ds_read_b128 v[28:31], v191 offset:12288
    s_waitcnt lgkmcnt(3)
    buffer_store_dwordx4 v[16:19], v247, s[4:7], s83 offen sc1
    s_add_u32 s83, s83, 0x1000
    s_waitcnt lgkmcnt(2)
    buffer_store_dwordx4 v[20:23], v247, s[4:7], s83 offen sc1
    s_add_u32 s83, s83, 0x1000
    s_waitcnt lgkmcnt(1)
    buffer_store_dwordx4 v[24:27], v247, s[4:7], s83 offen sc1
    s_add_u32 s83, s83, 0x1000
    s_waitcnt lgkmcnt(0)
    buffer_store_dwordx4 v[28:31], v247, s[4:7], s83 offen sc1
    s_waitcnt vmcnt(0) lgkmcnt(0)
    s_barrier
    s_cmp_lg_u32 s32, 0
    s_cbranch_scc1 L_pub_done
    s_add_u32 s39, s39, s34
    v_mov_b32 v170, 1
    v_mov_b32 v171, s39
    s_mov_b64 exec, 1
    buffer_store_byte v170, v171, s[68:71], 0 offen sc1
    s_mov_b64 exec, -1
L_pub_done:
L_go:
    ds_read_b128 a[192:195], v165 offset:8192
    ds_read_b128 a[196:199], v165 offset:9216
    ds_read_b128 a[200:203], v165 offset:10240
    ds_read_b128 a[204:207], v165 offset:11264
    ds_read_b128 a[208:211], v165 offset:12288
    ds_read_b128 a[212:215], v165 offset:13312
    ds_read_b128 a[216:219], v165 offset:14336
    ds_read_b128 a[220:223], v165 offset:15360
    s_waitcnt lgkmcnt(7)
    v_mfma_f32_16x16x32_bf16 v[0:3], a[192:195], a[128:131], 0
    s_waitcnt lgkmcnt(6)
    v_mfma_f32_16x16x32_bf16 v[0:3], a[196:199], a[132:135], v[0:3]
    s_waitcnt lgkmcnt(5)
    v_mfma_f32_16x16x32_bf16 v[0:3], a[200:203], a[136:139], v[0:3]
    s_waitcnt lgkmcnt(4)
    v_mfma_f32_16x16x32_bf16 v[0:3], a[204:207], a[140:143], v[0:3]
    v_mfma_f32_16x16x32_bf16 v[4:7], a[192:195], a[144:147], 0
    v_mfma_f32_16x16x32_bf16 v[4:7], a[196:199], a[148:151], v[4:7]
    v_mfma_f32_16x16x32_bf16 v[4:7], a[200:203], a[152:155], v[4:7]
    v_mfma_f32_16x16x32_bf16 v[4:7], a[204:207], a[156:159], v[4:7]
    v_mfma_f32_16x16x32_bf16 v[8:11], a[192:195], a[160:163], 0
    v_mfma_f32_16x16x32_bf16 v[8:11], a[196:199], a[164:167], v[8:11]
    v_mfma_f32_16x16x32_bf16 v[8:11], a[200:203], a[168:171], v[8:11]
    v_mfma_f32_16x16x32_bf16 v[8:11], a[204:207], a[172:175], v[8:11]
    v_mfma_f32_16x16x32_bf16 v[12:15], a[192:195], a[176:179], 0
    ds_read_b128 a[192:195], v165 offset:0
    v_mfma_f32_16x16x32_bf16 v[12:15], a[196:199], a[180:183], v[12:15]
    ds_read_b128 a[196:199], v165 offset:1024
    v_mfma_f32_16x16x32_bf16 v[12:15], a[200:203], a[184:187], v[12:15]
    ds_read_b128 a[200:203], v165 offset:2048
    v_mfma_f32_16x16x32_bf16 v[12:15], a[204:207], a[188:191], v[12:15]
    ds_read_b128 a[204:207], v165 offset:3072
    s_waitcnt lgkmcnt(4)
    v_mfma_f32_16x16x32_bf16 v[16:19], a[208:211], a[128:131], 0
    v_mfma_f32_16x16x32_bf16 v[16:19], a[212:215], a[132:135], v[16:19]
    v_mfma_f32_16x16x32_bf16 v[16:19], a[216:219], a[136:139], v[16:19]
    v_mfma_f32_16x16x32_bf16 v[16:19], a[220:223], a[140:143], v[16:19]
    v_mfma_f32_16x16x32_bf16 v[20:23], a[208:211], a[144:147], 0
    v_mfma_f32_16x16x32_bf16 v[20:23], a[212:215], a[148:151], v[20:23]
    v_mfma_f32_16x16x32_bf16 v[20:23], a[216:219], a[152:155], v[20:23]
    v_mfma_f32_16x16x32_bf16 v[20:23], a[220:223], a[156:159], v[20:23]
    v_mfma_f32_16x16x32_bf16 v[24:27], a[208:211], a[160:163], 0
    v_mfma_f32_16x16x32_bf16 v[24:27], a[212:215], a[164:167], v[24:27]
    v_mfma_f32_16x16x32_bf16 v[24:27], a[216:219], a[168:171], v[24:27]
    v_mfma_f32_16x16x32_bf16 v[24:27], a[220:223], a[172:175], v[24:27]
    v_mfma_f32_16x16x32_bf16 v[28:31], a[208:211], a[176:179], 0
    ds_read_b128 a[208:211], v165 offset:4096
    v_mfma_f32_16x16x32_bf16 v[28:31], a[212:215], a[180:183], v[28:31]
    ds_read_b128 a[212:215], v165 offset:5120
    v_mfma_f32_16x16x32_bf16 v[28:31], a[216:219], a[184:187], v[28:31]
    ds_read_b128 a[216:219], v165 offset:6144
    v_mfma_f32_16x16x32_bf16 v[28:31], a[220:223], a[188:191], v[28:31]
    ds_read_b128 a[220:223], v165 offset:7168
    s_waitcnt lgkmcnt(4)
    v_mfma_f32_16x16x32_bf16 v[32:35], a[192:195], a[128:131], 0
    v_mfma_f32_16x16x32_bf16 v[32:35], a[196:199], a[132:135], v[32:35]
    v_mfma_f32_16x16x32_bf16 v[32:35], a[200:203], a[136:139], v[32:35]
    v_mfma_f32_16x16x32_bf16 v[32:35], a[204:207], a[140:143], v[32:35]
    v_mfma_f32_16x16x32_bf16 v[36:39], a[192:195], a[144:147], 0
    v_mfma_f32_16x16x32_bf16 v[36:39], a[196:199], a[148:151], v[36:39]
    v_mfma_f32_16x16x32_bf16 v[36:39], a[200:203], a[152:155], v[36:39]
    v_mfma_f32_16x16x32_bf16 v[36:39], a[204:207], a[156:159], v[36:39]
    v_mfma_f32_16x16x32_bf16 v[40:43], a[192:195], a[160:163], 0
    v_mfma_f32_16x16x32_bf16 v[40:43], a[196:199], a[164:167], v[40:43]
    v_mfma_f32_16x16x32_bf16 v[40:43], a[200:203], a[168:171], v[40:43]
    v_mfma_f32_16x16x32_bf16 v[40:43], a[204:207], a[172:175], v[40:43]
    v_mfma_f32_16x16x32_bf16 v[44:47], a[192:195], a[176:179], 0
    v_mfma_f32_16x16x32_bf16 v[44:47], a[196:199], a[180:183], v[44:47]
    v_mfma_f32_16x16x32_bf16 v[44:47], a[200:203], a[184:187], v[44:47]
    v_mfma_f32_16x16x32_bf16 v[44:47], a[204:207], a[188:191], v[44:47]
    s_waitcnt lgkmcnt(0)
    v_mfma_f32_16x16x32_bf16 v[48:51], a[208:211], a[128:131], 0
    v_mfma_f32_16x16x32_bf16 v[48:51], a[212:215], a[132:135], v[48:51]
    v_mfma_f32_16x16x32_bf16 v[48:51], a[216:219], a[136:139], v[48:51]
    v_mfma_f32_16x16x32_bf16 v[48:51], a[220:223], a[140:143], v[48:51]
    v_mfma_f32_16x16x32_bf16 v[52:55], a[208:211], a[144:147], 0
    v_mfma_f32_16x16x32_bf16 v[52:55], a[212:215], a[148:151], v[52:55]
    v_mfma_f32_16x16x32_bf16 v[52:55], a[216:219], a[152:155], v[52:55]
    v_mfma_f32_16x16x32_bf16 v[52:55], a[220:223], a[156:159], v[52:55]
    v_mfma_f32_16x16x32_bf16 v[56:59], a[208:211], a[160:163], 0
    v_mfma_f32_16x16x32_bf16 v[56:59], a[212:215], a[164:167], v[56:59]
    v_mfma_f32_16x16x32_bf16 v[56:59], a[216:219], a[168:171], v[56:59]
    v_mfma_f32_16x16x32_bf16 v[56:59], a[220:223], a[172:175], v[56:59]
    v_mfma_f32_16x16x32_bf16 v[60:63], a[208:211], a[176:179], 0
    v_mfma_f32_16x16x32_bf16 v[60:63], a[212:215], a[180:183], v[60:63]
    v_mfma_f32_16x16x32_bf16 v[60:63], a[216:219], a[184:187], v[60:63]
    v_mfma_f32_16x16x32_bf16 v[60:63], a[220:223], a[188:191], v[60:63]
    s_nop 15
    v_max3_f32 v170, v0, v1, v2
    v_max3_f32 v170, v170, v3, v16
    v_max3_f32 v170, v170, v17, v18
    v_max3_f32 v170, v170, v19, v32
    v_max3_f32 v170, v170, v33, v34
    v_max3_f32 v170, v170, v35, v48
    v_max3_f32 v170, v170, v49, v50
    v_max_f32 v170, v170, v51
    v_max3_f32 v172, v4, v5, v6
    v_max3_f32 v172, v172, v7, v20
    v_max3_f32 v172, v172, v21, v22
    v_max3_f32 v172, v172, v23, v36
    v_max3_f32 v172, v172, v37, v38
    v_max3_f32 v172, v172, v39, v52
    v_max3_f32 v172, v172, v53, v54
    v_max_f32 v172, v172, v55
    v_max3_f32 v174, v8, v9, v10
    v_max3_f32 v174, v174, v11, v24
    v_max3_f32 v174, v174, v25, v26
    v_max3_f32 v174, v174, v27, v40
    v_max3_f32 v174, v174, v41, v42
    v_max3_f32 v174, v174, v43, v56
    v_max3_f32 v174, v174, v57, v58
    v_max_f32 v174, v174, v59
    v_max3_f32 v176, v12, v13, v14
    v_max3_f32 v176, v176, v15, v28
    v_max3_f32 v176, v176, v29, v30
    v_max3_f32 v176, v176, v31, v44
    v_max3_f32 v176, v176, v45, v46
    v_max3_f32 v176, v176, v47, v60
    v_max3_f32 v176, v176, v61, v62
    v_max_f32 v176, v176, v63
    v_mov_b32 v171, v170
    v_mov_b32 v173, v172
    v_mov_b32 v175, v174
    v_mov_b32 v177, v176
    s_nop 1
    v_permlane16_swap_b32 v170, v171
    v_permlane16_swap_b32 v172, v173
    v_permlane16_swap_b32 v174, v175
    v_permlane16_swap_b32 v176, v177
    s_nop 1
    v_max_f32 v170, v170, v171
    v_max_f32 v172, v172, v173
    v_max_f32 v174, v174, v175
    v_max_f32 v176, v176, v177
    v_mov_b32 v171, v170
    v_mov_b32 v173, v172
    v_mov_b32 v175, v174
    v_mov_b32 v177, v176
    s_nop 1
    v_permlane32_swap_b32 v170, v171
    v_permlane32_swap_b32 v172, v173
    v_permlane32_swap_b32 v174, v175
    v_permlane32_swap_b32 v176, v177
    s_nop 1
    v_max_f32 v170, v170, v171
    v_max_f32 v172, v172, v173
    v_max_f32 v174, v174, v175
    v_max_f32 v176, v176, v177
    v_sub_f32 v64, 0, v170
    v_sub_f32 v65, 0, v170
    v_sub_f32 v66, 0, v170
    v_sub_f32 v67, 0, v170
    v_sub_f32 v68, 0, v172
    v_sub_f32 v69, 0, v172
    v_sub_f32 v70, 0, v172
    v_sub_f32 v71, 0, v172
    v_sub_f32 v72, 0, v174
    v_sub_f32 v73, 0, v174
    v_sub_f32 v74, 0, v174
    v_sub_f32 v75, 0, v174
    v_sub_f32 v76, 0, v176
    v_sub_f32 v77, 0, v176
    v_sub_f32 v78, 0, v176
    v_sub_f32 v79, 0, v176
    v_add_f32 v0, v0, v64
    v_add_f32 v1, v1, v64
    v_add_f32 v2, v2, v64
    v_add_f32 v3, v3, v64
    v_add_f32 v4, v4, v68
    v_add_f32 v5, v5, v68
    v_add_f32 v6, v6, v68
    v_add_f32 v7, v7, v68
    v_add_f32 v8, v8, v72
    v_add_f32 v9, v9, v72
    v_add_f32 v10, v10, v72
    v_add_f32 v11, v11, v72
    v_add_f32 v12, v12, v76
    v_add_f32 v13, v13, v76
    v_add_f32 v14, v14, v76
    v_add_f32 v15, v15, v76
    v_add_f32 v16, v16, v64
    v_add_f32 v17, v17, v64
    v_add_f32 v18, v18, v64
    v_add_f32 v19, v19, v64
    v_add_f32 v20, v20, v68
    v_add_f32 v21, v21, v68
    v_add_f32 v22, v22, v68
    v_add_f32 v23, v23, v68
    v_add_f32 v24, v24, v72
    v_add_f32 v25, v25, v72
    v_add_f32 v26, v26, v72
    v_add_f32 v27, v27, v72
    v_add_f32 v28, v28, v76
    v_add_f32 v29, v29, v76
    v_add_f32 v30, v30, v76
    v_add_f32 v31, v31, v76
    v_add_f32 v32, v32, v64
    v_add_f32 v33, v33, v64
    v_add_f32 v34, v34, v64
    v_add_f32 v35, v35, v64
    v_add_f32 v36, v36, v68
    v_add_f32 v37, v37, v68
    v_add_f32 v38, v38, v68
    v_add_f32 v39, v39, v68
    v_add_f32 v40, v40, v72
    v_add_f32 v41, v41, v72
    v_add_f32 v42, v42, v72
    v_add_f32 v43, v43, v72
    v_add_f32 v44, v44, v76
    v_add_f32 v45, v45, v76
    v_add_f32 v46, v46, v76
    v_add_f32 v47, v47, v76
    v_add_f32 v48, v48, v64
    v_add_f32 v49, v49, v64
    v_add_f32 v50, v50, v64
    v_add_f32 v51, v51, v64
    v_add_f32 v52, v52, v68
    v_add_f32 v53, v53, v68
    v_add_f32 v54, v54, v68
    v_add_f32 v55, v55, v68
    v_add_f32 v56, v56, v72
    v_add_f32 v57, v57, v72
    v_add_f32 v58, v58, v72
    v_add_f32 v59, v59, v72
    v_add_f32 v60, v60, v76
    v_add_f32 v61, v61, v76
    v_add_f32 v62, v62, v76
    v_add_f32 v63, v63, v76
    v_exp_f32 v0, v0
    v_exp_f32 v1, v1
    v_exp_f32 v2, v2
    v_cvt_pk_bf16_f32 v96, v0, v1
    v_exp_f32 v3, v3
    v_exp_f32 v4, v4
    v_cvt_pk_bf16_f32 v97, v2, v3
    v_exp_f32 v5, v5
    v_exp_f32 v6, v6
    v_cvt_pk_bf16_f32 v100, v4, v5
    v_exp_f32 v7, v7
    v_exp_f32 v8, v8
    v_cvt_pk_bf16_f32 v101, v6, v7
    v_exp_f32 v9, v9
    v_exp_f32 v10, v10
    v_cvt_pk_bf16_f32 v104, v8, v9
    v_exp_f32 v11, v11
    v_exp_f32 v12, v12
    v_cvt_pk_bf16_f32 v105, v10, v11
    v_exp_f32 v13, v13
    v_exp_f32 v14, v14
    v_cvt_pk_bf16_f32 v108, v12, v13
    v_exp_f32 v15, v15
    v_exp_f32 v16, v16
    v_cvt_pk_bf16_f32 v109, v14, v15
    v_exp_f32 v17, v17
    v_exp_f32 v18, v18
    v_cvt_pk_bf16_f32 v98, v16, v17
    v_exp_f32 v19, v19
    v_exp_f32 v20, v20
    v_cvt_pk_bf16_f32 v99, v18, v19
    v_exp_f32 v21, v21
    v_exp_f32 v22, v22
    v_cvt_pk_bf16_f32 v102, v20, v21
    v_exp_f32 v23, v23
    v_exp_f32 v24, v24
    v_cvt_pk_bf16_f32 v103, v22, v23
    v_exp_f32 v25, v25
    v_exp_f32 v26, v26
    v_cvt_pk_bf16_f32 v106, v24, v25
    v_exp_f32 v27, v27
    v_exp_f32 v28, v28
    v_cvt_pk_bf16_f32 v107, v26, v27
    v_exp_f32 v29, v29
    v_exp_f32 v30, v30
    v_cvt_pk_bf16_f32 v110, v28, v29
    v_exp_f32 v31, v31
    v_exp_f32 v32, v32
    v_cvt_pk_bf16_f32 v111, v30, v31
    v_exp_f32 v33, v33
    v_exp_f32 v34, v34
    v_cvt_pk_bf16_f32 v112, v32, v33
    v_exp_f32 v35, v35
    v_exp_f32 v36, v36
    v_cvt_pk_bf16_f32 v113, v34, v35
    v_exp_f32 v37, v37
    v_exp_f32 v38, v38
    v_cvt_pk_bf16_f32 v116, v36, v37
    v_exp_f32 v39, v39
    v_exp_f32 v40, v40
    v_cvt_pk_bf16_f32 v117, v38, v39
    v_exp_f32 v41, v41
    v_exp_f32 v42, v42
    v_cvt_pk_bf16_f32 v120, v40, v41
    v_exp_f32 v43, v43
    v_exp_f32 v44, v44
    v_cvt_pk_bf16_f32 v121, v42, v43
    v_exp_f32 v45, v45
    v_exp_f32 v46, v46
    v_cvt_pk_bf16_f32 v124, v44, v45
    v_exp_f32 v47, v47
    s_nop 0
    v_cvt_pk_bf16_f32 v125, v46, v47
    v_mov_b32 v172, 135232
    s_cmp_lg_u32 s32, 0
    s_cbranch_scc1 L_pw1
    s_mov_b32 s90, 1
    s_cmp_lg_u32 s92, 0
    s_cbranch_scc1 L_pok1
    s_mov_b32 s91, 0
L_poll1:
    buffer_load_ubyte v170, v190, s[68:71], 0 offen sc1
    s_waitcnt vmcnt(0)
    v_cmp_eq_u32 s[40:41], 0, v170
    v_or_b32 v170, v170, v246
    v_cmp_eq_u32 vcc, 0, v170
    s_add_u32 s91, s91, 1
    s_nop 3
    s_cbranch_vccz L_pdone1
    s_sleep 1
    s_cmp_lt_u32 s91, 6000
    s_cbranch_scc1 L_poll1
    s_mov_b32 s90, 2
L_pdone1:
L_pok1:
    v_mov_b32 v170, s90
    ds_write_b32 v172, v170
L_pw1:
    s_waitcnt lgkmcnt(0)
    s_barrier
    ds_read_b32 v170, v172
    s_waitcnt lgkmcnt(0)
    v_readfirstlane_b32 s90, v170
    s_nop 3
    s_cmp_eq_u32 s90, 2
    s_cbranch_scc1 L_selfhelp
    s_lshl_b32 s17, s34, 15
    s_lshr_b32 s75, s23, 2
    s_add_u32 m0, s75, 24576
    s_sub_u32 s75, s75, s23
    s_add_u32 s75, s75, 24576
    s_add_u32 s75, s75, s17
    buffer_load_dwordx4 v168, s[4:7], s75 offen offset:0 sc1 lds
    buffer_load_dwordx4 v168, s[4:7], s75 offen offset:1024 sc1 lds
    s_add_u32 s17, s17, 0x8000
    s_and_b32 s17, s17, 0xfffff
    s_add_u32 s19, s23, 0x8000
    s_mov_b32 m0, s19
    s_nop 0
    buffer_load_dwordx4 v168, s[4:7], s17 offen offset:0 sc1 lds
    buffer_load_dwordx4 v168, s[4:7], s17 offen offset:1024 sc1 lds
    buffer_load_dwordx4 v168, s[4:7], s17 offen offset:2048 sc1 lds
    buffer_load_dwordx4 v168, s[4:7], s17 offen offset:3072 sc1 lds
    s_add_u32 m0, s19, 0x1000
    s_nop 0
    buffer_load_dwordx4 v169, s[4:7], s17 offen offset:0 sc1 lds
    buffer_load_dwordx4 v169, s[4:7], s17 offen offset:1024 sc1 lds
    buffer_load_dwordx4 v169, s[4:7], s17 offen offset:2048 sc1 lds
    buffer_load_dwordx4 v169, s[4:7], s17 offen offset:3072 sc1 lds
    s_add_u32 s17, s17, 0x8000
    s_and_b32 s17, s17, 0xfffff
    s_add_u32 s19, s19, 0x8000
    s_and_b32 s19, s19, 0x1ffff
    s_mov_b32 m0, s19
    s_nop 0
    buffer_load_dwordx4 v168, s[4:7], s17 offen offset:0 sc1 lds
    buffer_load_dwordx4 v168, s[4:7], s17 offen offset:1024 sc1 lds
    buffer_load_dwordx4 v168, s[4:7], s17 offen offset:2048 sc1 lds
    buffer_load_dwordx4 v168, s[4:7], s17 offen offset:3072 sc1 lds
    s_add_u32 m0, s19, 0x1000
    s_nop 0
    buffer_load_dwordx4 v169, s[4:7], s17 offen offset:0 sc1 lds
    buffer_load_dwordx4 v169, s[4:7], s17 offen offset:1024 sc1 lds
    buffer_load_dwordx4 v169, s[4:7], s17 offen offset:2048 sc1 lds
    buffer_load_dwordx4 v169, s[4:7], s17 offen offset:3072 sc1 lds
    s_add_u32 s17, s17, 0x8000
    s_and_b32 s17, s17, 0xfffff
    s_add_u32 s19, s19, 0x8000
    s_and_b32 s19, s19, 0x1ffff
    s_mov_b32 m0, s19
    s_nop 0
    buffer_load_dwordx4 v168, s[4:7], s17 offen offset:0 sc1 lds
    buffer_load_dwordx4 v168, s[4:7], s17 offen offset:1024 sc1 lds
    buffer_load_dwordx4 v168, s[4:7], s17 offen offset:2048 sc1 lds
    buffer_load_dwordx4 v168, s[4:7], s17 offen offset:3072 sc1 lds
    s_add_u32 m0, s19, 0x1000
    s_nop 0
    buffer_load_dwordx4 v169, s[4:7], s17 offen offset:0 sc1 lds
    buffer_load_dwordx4 v169, s[4:7], s17 offen offset:1024 sc1 lds
    buffer_load_dwordx4 v169, s[4:7], s17 offen offset:2048 sc1 lds
    buffer_load_dwordx4 v169, s[4:7], s17 offen offset:3072 sc1 lds
    s_add_u32 s17, s17, 0x8000
    s_and_b32 s17, s17, 0xfffff
    s_add_u32 s19, s19, 0x8000
    s_and_b32 s19, s19, 0x1ffff
    v_mov_b32 v172, 135296
    s_cmp_lg_u32 s32, 0
    s_cbranch_scc1 L_pw2
    s_mov_b32 s90, 1
    s_cmp_lg_u32 s92, 0
    s_cbranch_scc1 L_pok2
    s_cmp_eq_u64 s[40:41], 0
    s_cbranch_scc1 L_pok2
    s_mov_b32 s91, 0
L_poll2:
    buffer_load_ubyte v170, v190, s[68:71], 0 offen sc1
    s_waitcnt vmcnt(0)
    v_cmp_eq_u32 vcc, 0, v170
    s_add_u32 s91, s91, 1
    s_nop 3
    s_cbranch_vccz L_pdone2
    s_sleep 1
    s_cmp_lt_u32 s91, 6000
    s_cbranch_scc1 L_poll2
    s_mov_b32 s90, 2
L_pdone2:
L_pok2:
    v_mov_b32 v170, s90
    ds_write_b32 v172, v170
L_pw2:
    s_waitcnt vmcnt(24) lgkmcnt(0)
    s_barrier
    ds_read_b32 v170, v172
    s_waitcnt lgkmcnt(0)
    v_readfirstlane_b32 s90, v170
    s_nop 3
    s_cmp_eq_u32 s90, 2
    s_cbranch_scc1 L_selfhelp
    ds_read_b128 a[192:195], v165 offset:24576
    ds_read_b128 a[196:199], v165 offset:25600
    ds_read_b128 a[200:203], v165 offset:26624
    ds_read_b128 a[204:207], v165 offset:27648
    ds_read_b128 a[208:211], v165 offset:28672
    ds_read_b128 a[212:215], v165 offset:29696
    ds_read_b128 a[216:219], v165 offset:30720
    ds_read_b128 a[220:223], v165 offset:31744
    s_waitcnt lgkmcnt(0)
    s_mov_b32 s16, 15
.p2align 6
L_loop:
    v_mfma_f32_16x16x32_bf16 v[0:3], a[192:195], a[128:131], v[64:67]
    v_exp_f32 v48, v48
    v_mfma_f32_16x16x32_bf16 v[0:3], a[196:199], a[132:135], v[0:3]
    s_waitcnt lgkmcnt(2)
    v_cvt_pk_bf16_f32 v120, v40, v41
    v_mfma_f32_16x16x32_bf16 v[0:3], a[200:203], a[136:139], v[0:3]
    v_exp_f32 v49, v49
    v_mfma_f32_16x16x32_bf16 v[0:3], a[204:207], a[140:143], v[0:3]
    v_cvt_pk_bf16_f32 v121, v42, v43
    v_mfma_f32_16x16x32_bf16 v[4:7], a[192:195], a[144:147], v[68:71]
    v_exp_f32 v50, v50
    v_mfma_f32_16x16x32_bf16 v[4:7], a[196:199], a[148:151], v[4:7]
    v_cvt_pk_bf16_f32 v124, v44, v45
    v_mfma_f32_16x16x32_bf16 v[4:7], a[200:203], a[152:155], v[4:7]
    v_exp_f32 v51, v51
    v_mfma_f32_16x16x32_bf16 v[4:7], a[204:207], a[156:159], v[4:7]
    v_cvt_pk_bf16_f32 v125, v46, v47
    v_mfma_f32_16x16x32_bf16 v[8:11], a[192:195], a[160:163], v[72:75]
    v_exp_f32 v52, v52
    v_mfma_f32_16x16x32_bf16 v[8:11], a[196:199], a[164:167], v[8:11]
    v_cvt_pk_bf16_f32 v114, v48, v49
    v_mfma_f32_16x16x32_bf16 v[8:11], a[200:203], a[168:171], v[8:11]
    v_cvt_pk_bf16_f32 v115, v50, v51
    v_mfma_f32_16x16x32_bf16 v[8:11], a[204:207], a[172:175], v[8:11]
    s_waitcnt vmcnt(16) lgkmcnt(0)
    s_barrier
    v_mfma_f32_16x16x32_bf16 v[12:15], a[192:195], a[176:179], v[76:79]
    v_exp_f32 v53, v53
    v_mfma_f32_16x16x32_bf16 v[12:15], a[196:199], a[180:183], v[12:15]
    ds_read_b128 a[192:195], v165 offset:32768
    s_mov_b32 m0, s19
    v_mfma_f32_16x16x32_bf16 v[12:15], a[200:203], a[184:187], v[12:15]
    v_exp_f32 v54, v54
    v_mfma_f32_16x16x32_bf16 v[12:15], a[204:207], a[188:191], v[12:15]
    ds_read_b128 a[196:199], v165 offset:33792
    v_mfma_f32_16x16x32_bf16 v[16:19], a[208:211], a[128:131], v[64:67]
    v_exp_f32 v55, v55
    v_mfma_f32_16x16x32_bf16 v[16:19], a[212:215], a[132:135], v[16:19]
    ds_read_b128 a[200:203], v165 offset:34816
    v_mfma_f32_16x16x32_bf16 v[16:19], a[216:219], a[136:139], v[16:19]
    v_exp_f32 v56, v56
    v_mfma_f32_16x16x32_bf16 v[16:19], a[220:223], a[140:143], v[16:19]
    ds_read_b128 a[204:207], v165 offset:35840
    v_mfma_f32_16x16x32_bf16 v[20:23], a[208:211], a[144:147], v[68:71]
    v_exp_f32 v57, v57
    v_mfma_f32_16x16x32_bf16 v[20:23], a[212:215], a[148:151], v[20:23]
    buffer_load_dwordx4 v168, s[4:7], s17 offen offset:0 sc1 lds
    v_mfma_f32_16x16x32_bf16 v[20:23], a[216:219], a[152:155], v[20:23]
    v_exp_f32 v58, v58
    v_mfma_f32_16x16x32_bf16 v[20:23], a[220:223], a[156:159], v[20:23]
    v_cvt_pk_bf16_f32 v118, v52, v53
    v_mfma_f32_16x16x32_bf16 v[24:27], a[208:211], a[160:163], v[72:75]
    v_exp_f32 v59, v59
    v_mfma_f32_16x16x32_bf16 v[24:27], a[212:215], a[164:167], v[24:27]
    v_cvt_pk_bf16_f32 v119, v54, v55
    v_mfma_f32_16x16x32_bf16 v[24:27], a[216:219], a[168:171], v[24:27]
    v_exp_f32 v60, v60
    v_mfma_f32_16x16x32_bf16 v[24:27], a[220:223], a[172:175], v[24:27]
    v_cvt_pk_bf16_f32 v122, v56, v57
    v_mfma_f32_16x16x32_bf16 v[28:31], a[208:211], a[176:179], v[76:79]
    v_exp_f32 v61, v61
    v_mfma_f32_16x16x32_bf16 v[28:31], a[212:215], a[180:183], v[28:31]
    ds_read_b128 a[208:211], v165 offset:36864
    v_mfma_f32_16x16x32_bf16 v[28:31], a[216:219], a[184:187], v[28:31]
    v_exp_f32 v62, v62
    v_mfma_f32_16x16x32_bf16 v[28:31], a[220:223], a[188:191], v[28:31]
    s_waitcnt lgkmcnt(1)
    ds_read_b128 a[212:215], v165 offset:37888
    v_mfma_f32_16x16x32_bf16 v[32:35], a[192:195], a[128:131], v[64:67]
    v_exp_f32 v63, v63
    v_mfma_f32_16x16x32_bf16 v[32:35], a[196:199], a[132:135], v[32:35]
    ds_read_b128 a[216:219], v165 offset:38912
    v_mfma_f32_16x16x32_bf16 v[32:35], a[200:203], a[136:139], v[32:35]
    v_exp_f32 v0, v0
    v_mfma_f32_16x16x32_bf16 v[32:35], a[204:207], a[140:143], v[32:35]
    ds_read_b128 a[220:223], v165 offset:39936
    v_mfma_f32_16x16x32_bf16 v[36:39], a[192:195], a[144:147], v[68:71]
    v_exp_f32 v1, v1
    v_mfma_f32_16x16x32_bf16 v[36:39], a[196:199], a[148:151], v[36:39]
    buffer_load_dwordx4 v168, s[4:7], s17 offen offset:1024 sc1 lds
    v_mfma_f32_16x16x32_bf16 v[36:39], a[200:203], a[152:155], v[36:39]
    v_exp_f32 v2, v2
    v_mfma_f32_16x16x32_bf16 v[36:39], a[204:207], a[156:159], v[36:39]
    v_cvt_pk_bf16_f32 v123, v58, v59
    v_mfma_f32_16x16x32_bf16 v[40:43], a[192:195], a[160:163], v[72:75]
    v_exp_f32 v3, v3
    v_mfma_f32_16x16x32_bf16 v[40:43], a[196:199], a[164:167], v[40:43]
    v_cvt_pk_bf16_f32 v126, v60, v61
    v_mfma_f32_16x16x32_bf16 v[40:43], a[200:203], a[168:171], v[40:43]
    v_exp_f32 v4, v4
    v_mfma_f32_16x16x32_bf16 v[40:43], a[204:207], a[172:175], v[40:43]
    v_cvt_pk_bf16_f32 v127, v62, v63
    v_mfma_f32_16x16x32_bf16 v[44:47], a[192:195], a[176:179], v[76:79]
    v_exp_f32 v5, v5
    v_mfma_f32_16x16x32_bf16 v[44:47], a[196:199], a[180:183], v[44:47]
    ds_read_b128 a[192:195], v165 offset:40960
    v_mfma_f32_16x16x32_bf16 v[44:47], a[200:203], a[184:187], v[44:47]
    s_waitcnt lgkmcnt(1)
    ds_read_b128 a[196:199], v165 offset:41984
    v_mfma_f32_16x16x32_bf16 v[44:47], a[204:207], a[188:191], v[44:47]
    ds_read_b128 a[200:203], v165 offset:43008
    v_mfma_f32_16x16x32_bf16 v[48:51], a[208:211], a[128:131], v[64:67]
    v_exp_f32 v6, v6
    v_mfma_f32_16x16x32_bf16 v[48:51], a[212:215], a[132:135], v[48:51]
    ds_read_b128 a[204:207], v165 offset:44032
    v_mfma_f32_16x16x32_bf16 v[48:51], a[216:219], a[136:139], v[48:51]
    v_exp_f32 v7, v7
    v_mfma_f32_16x16x32_bf16 v[48:51], a[220:223], a[140:143], v[48:51]
    v_cvt_pk_bf16_f32 v128, v0, v1
    v_mfma_f32_16x16x32_bf16 v[52:55], a[208:211], a[144:147], v[68:71]
    v_exp_f32 v8, v8
    v_mfma_f32_16x16x32_bf16 v[52:55], a[212:215], a[148:151], v[52:55]
    buffer_load_dwordx4 v168, s[4:7], s17 offen offset:2048 sc1 lds
    v_mfma_f32_16x16x32_bf16 v[52:55], a[216:219], a[152:155], v[52:55]
    v_exp_f32 v9, v9
    v_mfma_f32_16x16x32_bf16 v[52:55], a[220:223], a[156:159], v[52:55]
    v_cvt_pk_bf16_f32 v129, v2, v3
    v_mfma_f32_16x16x32_bf16 v[56:59], a[208:211], a[160:163], v[72:75]
    v_exp_f32 v10, v10
    v_mfma_f32_16x16x32_bf16 v[56:59], a[212:215], a[164:167], v[56:59]
    v_cvt_pk_bf16_f32 v132, v4, v5
    v_mfma_f32_16x16x32_bf16 v[56:59], a[216:219], a[168:171], v[56:59]
    v_exp_f32 v11, v11
    v_mfma_f32_16x16x32_bf16 v[56:59], a[220:223], a[172:175], v[56:59]
    v_cvt_pk_bf16_f32 v133, v6, v7
    v_mfma_f32_16x16x32_bf16 v[60:63], a[208:211], a[176:179], v[76:79]
    v_exp_f32 v12, v12
    v_mfma_f32_16x16x32_bf16 v[60:63], a[212:215], a[180:183], v[60:63]
    ds_read_b128 a[208:211], v165 offset:45056
    v_mfma_f32_16x16x32_bf16 v[60:63], a[216:219], a[184:187], v[60:63]
    v_exp_f32 v13, v13
    v_mfma_f32_16x16x32_bf16 v[60:63], a[220:223], a[188:191], v[60:63]
    ds_read_b128 a[212:215], v165 offset:46080
    v_mfma_f32_16x16x32_bf16 a[224:227], a[240:243], v[96:99], a[224:227]
    v_exp_f32 v14, v14
    v_mfma_f32_16x16x32_bf16 a[224:227], a[240:243], v[112:115], a[224:227]
    ds_read_b128 a[216:219], v165 offset:47104
    v_mfma_f32_16x16x32_bf16 a[228:231], a[240:243], v[100:103], a[228:231]
    v_exp_f32 v15, v15
    v_mfma_f32_16x16x32_bf16 a[228:231], a[240:243], v[116:119], a[228:231]
    ds_read_b128 a[220:223], v165 offset:48128
    v_mfma_f32_16x16x32_bf16 a[232:235], a[240:243], v[104:107], a[232:235]
    v_exp_f32 v16, v16
    v_mfma_f32_16x16x32_bf16 a[232:235], a[240:243], v[120:123], a[232:235]
    buffer_load_dwordx4 v168, s[4:7], s17 offen offset:3072 sc1 lds
    v_mfma_f32_16x16x32_bf16 a[236:239], a[240:243], v[108:111], a[236:239]
    v_exp_f32 v17, v17
    v_mfma_f32_16x16x32_bf16 a[236:239], a[240:243], v[124:127], a[236:239]
    s_waitcnt lgkmcnt(1)
    v_cvt_pk_bf16_f32 v136, v8, v9
    v_mfma_f32_16x16x32_bf16 a[0:3], a[192:195], v[96:99], a[0:3]
    v_exp_f32 v18, v18
    v_mfma_f32_16x16x32_bf16 a[0:3], a[196:199], v[112:115], a[0:3]
    v_cvt_pk_bf16_f32 v137, v10, v11
    s_add_u32 m0, s19, 0x1000
    v_mfma_f32_16x16x32_bf16 a[32:35], a[192:195], v[100:103], a[32:35]
    v_exp_f32 v19, v19
    v_mfma_f32_16x16x32_bf16 a[32:35], a[196:199], v[116:119], a[32:35]
    v_cvt_pk_bf16_f32 v140, v12, v13
    v_mfma_f32_16x16x32_bf16 a[64:67], a[192:195], v[104:107], a[64:67]
    v_exp_f32 v20, v20
    v_mfma_f32_16x16x32_bf16 a[64:67], a[196:199], v[120:123], a[64:67]
    v_cvt_pk_bf16_f32 v141, v14, v15
    v_mfma_f32_16x16x32_bf16 a[96:99], a[192:195], v[108:111], a[96:99]
    v_exp_f32 v21, v21
    v_mfma_f32_16x16x32_bf16 a[96:99], a[196:199], v[124:127], a[96:99]
    ds_read_b128 a[192:195], v165 offset:49152
    v_mfma_f32_16x16x32_bf16 a[4:7], a[200:203], v[96:99], a[4:7]
    v_exp_f32 v22, v22
    v_mfma_f32_16x16x32_bf16 a[4:7], a[204:207], v[112:115], a[4:7]
    ds_read_b128 a[196:199], v165 offset:50176
    v_mfma_f32_16x16x32_bf16 a[36:39], a[200:203], v[100:103], a[36:39]
    v_exp_f32 v23, v23
    v_mfma_f32_16x16x32_bf16 a[36:39], a[204:207], v[116:119], a[36:39]
    v_cvt_pk_bf16_f32 v130, v16, v17
    v_mfma_f32_16x16x32_bf16 a[68:71], a[200:203], v[104:107], a[68:71]
    v_exp_f32 v24, v24
    v_mfma_f32_16x16x32_bf16 a[68:71], a[204:207], v[120:123], a[68:71]
    buffer_load_dwordx4 v169, s[4:7], s17 offen offset:0 sc1 lds
    v_mfma_f32_16x16x32_bf16 a[100:103], a[200:203], v[108:111], a[100:103]
    v_exp_f32 v25, v25
    v_mfma_f32_16x16x32_bf16 a[100:103], a[204:207], v[124:127], a[100:103]
    ds_read_b128 a[200:203], v165 offset:51200
    v_mfma_f32_16x16x32_bf16 a[8:11], a[208:211], v[96:99], a[8:11]
    v_exp_f32 v26, v26
    v_mfma_f32_16x16x32_bf16 a[8:11], a[212:215], v[112:115], a[8:11]
    ds_read_b128 a[204:207], v165 offset:52224
    v_mfma_f32_16x16x32_bf16 a[40:43], a[208:211], v[100:103], a[40:43]
    v_cvt_pk_bf16_f32 v131, v18, v19
    v_mfma_f32_16x16x32_bf16 a[40:43], a[212:215], v[116:119], a[40:43]
    v_cvt_pk_bf16_f32 v134, v20, v21
    v_mfma_f32_16x16x32_bf16 a[72:75], a[208:211], v[104:107], a[72:75]
    v_exp_f32 v27, v27
    v_mfma_f32_16x16x32_bf16 a[72:75], a[212:215], v[120:123], a[72:75]
    v_cvt_pk_bf16_f32 v135, v22, v23
    v_mfma_f32_16x16x32_bf16 a[104:107], a[208:211], v[108:111], a[104:107]
    v_exp_f32 v28, v28
    v_mfma_f32_16x16x32_bf16 a[104:107], a[212:215], v[124:127], a[104:107]
    s_waitcnt lgkmcnt(0)
    ds_read_b128 a[208:211], v165 offset:53248
    v_mfma_f32_16x16x32_bf16 a[12:15], a[216:219], v[96:99], a[12:15]
    v_exp_f32 v29, v29
    v_mfma_f32_16x16x32_bf16 a[12:15], a[220:223], v[112:115], a[12:15]
    ds_read_b128 a[212:215], v165 offset:54272
    v_mfma_f32_16x16x32_bf16 a[44:47], a[216:219], v[100:103], a[44:47]
    v_exp_f32 v30, v30
    v_mfma_f32_16x16x32_bf16 a[44:47], a[220:223], v[116:119], a[44:47]
    v_cvt_pk_bf16_f32 v138, v24, v25
    v_mfma_f32_16x16x32_bf16 a[76:79], a[216:219], v[104:107], a[76:79]
    v_exp_f32 v31, v31
    v_mfma_f32_16x16x32_bf16 a[76:79], a[220:223], v[120:123], a[76:79]
    buffer_load_dwordx4 v169, s[4:7], s17 offen offset:1024 sc1 lds
    v_mfma_f32_16x16x32_bf16 a[108:111], a[216:219], v[108:111], a[108:111]
    v_exp_f32 v32, v32
    v_mfma_f32_16x16x32_bf16 a[108:111], a[220:223], v[124:127], a[108:111]
    ds_read_b128 a[216:219], v165 offset:55296
    v_mfma_f32_16x16x32_bf16 a[16:19], a[192:195], v[96:99], a[16:19]
    v_exp_f32 v33, v33
    v_mfma_f32_16x16x32_bf16 a[16:19], a[196:199], v[112:115], a[16:19]
    ds_read_b128 a[220:223], v165 offset:56320
    v_mfma_f32_16x16x32_bf16 a[48:51], a[192:195], v[100:103], a[48:51]
    v_exp_f32 v34, v34
    v_mfma_f32_16x16x32_bf16 a[48:51], a[196:199], v[116:119], a[48:51]
    v_cvt_pk_bf16_f32 v139, v26, v27
    v_mfma_f32_16x16x32_bf16 a[80:83], a[192:195], v[104:107], a[80:83]
    v_exp_f32 v35, v35
    v_mfma_f32_16x16x32_bf16 a[80:83], a[196:199], v[120:123], a[80:83]
    v_cvt_pk_bf16_f32 v142, v28, v29
    v_mfma_f32_16x16x32_bf16 a[112:115], a[192:195], v[108:111], a[112:115]
    v_exp_f32 v36, v36
    v_mfma_f32_16x16x32_bf16 a[112:115], a[196:199], v[124:127], a[112:115]
    ds_read_b128 a[192:195], v165 offset:57344
    v_mfma_f32_16x16x32_bf16 a[20:23], a[200:203], v[96:99], a[20:23]
    v_exp_f32 v37, v37
    v_mfma_f32_16x16x32_bf16 a[20:23], a[204:207], v[112:115], a[20:23]
    ds_read_b128 a[196:199], v165 offset:58368
    v_mfma_f32_16x16x32_bf16 a[52:55], a[200:203], v[100:103], a[52:55]
    v_exp_f32 v38, v38
    v_mfma_f32_16x16x32_bf16 a[52:55], a[204:207], v[116:119], a[52:55]
    v_cvt_pk_bf16_f32 v143, v30, v31
    v_mfma_f32_16x16x32_bf16 a[84:87], a[200:203], v[104:107], a[84:87]
    v_exp_f32 v39, v39
    v_mfma_f32_16x16x32_bf16 a[84:87], a[204:207], v[120:123], a[84:87]
    buffer_load_dwordx4 v169, s[4:7], s17 offen offset:2048 sc1 lds
    v_mfma_f32_16x16x32_bf16 a[116:119], a[200:203], v[108:111], a[116:119]
    v_exp_f32 v40, v40
    v_mfma_f32_16x16x32_bf16 a[116:119], a[204:207], v[124:127], a[116:119]
    s_waitcnt lgkmcnt(0)
    ds_read_b128 a[200:203], v165 offset:59392
    v_mfma_f32_16x16x32_bf16 a[24:27], a[208:211], v[96:99], a[24:27]
    v_exp_f32 v41, v41
    v_mfma_f32_16x16x32_bf16 a[24:27], a[212:215], v[112:115], a[24:27]
    ds_read_b128 a[204:207], v165 offset:60416
    v_cvt_pk_bf16_f32 v144, v32, v33
    v_mfma_f32_16x16x32_bf16 a[56:59], a[208:211], v[100:103], a[56:59]
    v_exp_f32 v42, v42
    v_mfma_f32_16x16x32_bf16 a[56:59], a[212:215], v[116:119], a[56:59]
    v_cvt_pk_bf16_f32 v145, v34, v35
    v_mfma_f32_16x16x32_bf16 a[88:91], a[208:211], v[104:107], a[88:91]
    v_exp_f32 v43, v43
    v_mfma_f32_16x16x32_bf16 a[88:91], a[212:215], v[120:123], a[88:91]
    v_cvt_pk_bf16_f32 v148, v36, v37
    v_mfma_f32_16x16x32_bf16 a[120:123], a[208:211], v[108:111], a[120:123]
    v_exp_f32 v44, v44
    v_mfma_f32_16x16x32_bf16 a[120:123], a[212:215], v[124:127], a[120:123]
    ds_read_b128 a[208:211], v165 offset:61440
    v_mfma_f32_16x16x32_bf16 a[28:31], a[216:219], v[96:99], a[28:31]
    v_exp_f32 v45, v45
    v_mfma_f32_16x16x32_bf16 a[28:31], a[220:223], v[112:115], a[28:31]
    ds_read_b128 a[212:215], v165 offset:62464
    v_mfma_f32_16x16x32_bf16 a[60:63], a[216:219], v[100:103], a[60:63]
    v_exp_f32 v46, v46
    v_mfma_f32_16x16x32_bf16 a[60:63], a[220:223], v[116:119], a[60:63]
    buffer_load_dwordx4 v169, s[4:7], s17 offen offset:3072 sc1 lds
    v_mfma_f32_16x16x32_bf16 a[92:95], a[216:219], v[104:107], a[92:95]
    v_exp_f32 v47, v47
    v_mfma_f32_16x16x32_bf16 a[92:95], a[220:223], v[120:123], a[92:95]
    v_cvt_pk_bf16_f32 v149, v38, v39
    s_add_u32 s17, s17, 0x8000
    v_mfma_f32_16x16x32_bf16 a[124:127], a[216:219], v[108:111], a[124:127]
    ds_read_b128 a[216:219], v165 offset:63488
    s_and_b32 s17, s17, 0xfffff
    v_mfma_f32_16x16x32_bf16 a[124:127], a[220:223], v[124:127], a[124:127]
    ds_read_b128 a[220:223], v165 offset:64512
    s_add_u32 s19, s19, 0x8000
    s_and_b32 s19, s19, 0x1ffff
    v_xor_b32 v165, 0x10000, v165
    v_mfma_f32_16x16x32_bf16 v[0:3], a[192:195], a[128:131], v[64:67]
    v_exp_f32 v48, v48
    v_mfma_f32_16x16x32_bf16 v[0:3], a[196:199], a[132:135], v[0:3]
    s_waitcnt lgkmcnt(2)
    v_cvt_pk_bf16_f32 v152, v40, v41
    v_mfma_f32_16x16x32_bf16 v[0:3], a[200:203], a[136:139], v[0:3]
    v_exp_f32 v49, v49
    v_mfma_f32_16x16x32_bf16 v[0:3], a[204:207], a[140:143], v[0:3]
    v_cvt_pk_bf16_f32 v153, v42, v43
    v_mfma_f32_16x16x32_bf16 v[4:7], a[192:195], a[144:147], v[68:71]
    v_exp_f32 v50, v50
    v_mfma_f32_16x16x32_bf16 v[4:7], a[196:199], a[148:151], v[4:7]
    v_cvt_pk_bf16_f32 v156, v44, v45
    v_mfma_f32_16x16x32_bf16 v[4:7], a[200:203], a[152:155], v[4:7]
    v_exp_f32 v51, v51
    v_mfma_f32_16x16x32_bf16 v[4:7], a[204:207], a[156:159], v[4:7]
    v_cvt_pk_bf16_f32 v157, v46, v47
    v_mfma_f32_16x16x32_bf16 v[8:11], a[192:195], a[160:163], v[72:75]
    v_exp_f32 v52, v52
    v_mfma_f32_16x16x32_bf16 v[8:11], a[196:199], a[164:167], v[8:11]
    v_cvt_pk_bf16_f32 v146, v48, v49
    v_mfma_f32_16x16x32_bf16 v[8:11], a[200:203], a[168:171], v[8:11]
    v_cvt_pk_bf16_f32 v147, v50, v51
    v_mfma_f32_16x16x32_bf16 v[8:11], a[204:207], a[172:175], v[8:11]
    s_waitcnt vmcnt(16) lgkmcnt(0)
    s_barrier
    v_mfma_f32_16x16x32_bf16 v[12:15], a[192:195], a[176:179], v[76:79]
    v_exp_f32 v53, v53
    v_mfma_f32_16x16x32_bf16 v[12:15], a[196:199], a[180:183], v[12:15]
    ds_read_b128 a[192:195], v165 offset:0
    s_mov_b32 m0, s19
    v_mfma_f32_16x16x32_bf16 v[12:15], a[200:203], a[184:187], v[12:15]
    v_exp_f32 v54, v54
    v_mfma_f32_16x16x32_bf16 v[12:15], a[204:207], a[188:191], v[12:15]
    ds_read_b128 a[196:199], v165 offset:1024
    v_mfma_f32_16x16x32_bf16 v[16:19], a[208:211], a[128:131], v[64:67]
    v_exp_f32 v55, v55
    v_mfma_f32_16x16x32_bf16 v[16:19], a[212:215], a[132:135], v[16:19]
    ds_read_b128 a[200:203], v165 offset:2048
    v_mfma_f32_16x16x32_bf16 v[16:19], a[216:219], a[136:139], v[16:19]
    v_exp_f32 v56, v56
    v_mfma_f32_16x16x32_bf16 v[16:19], a[220:223], a[140:143], v[16:19]
    ds_read_b128 a[204:207], v165 offset:3072
    v_mfma_f32_16x16x32_bf16 v[20:23], a[208:211], a[144:147], v[68:71]
    v_exp_f32 v57, v57
    v_mfma_f32_16x16x32_bf16 v[20:23], a[212:215], a[148:151], v[20:23]
    buffer_load_dwordx4 v168, s[4:7], s17 offen offset:0 sc1 lds
    v_mfma_f32_16x16x32_bf16 v[20:23], a[216:219], a[152:155], v[20:23]
    v_exp_f32 v58, v58
    v_mfma_f32_16x16x32_bf16 v[20:23], a[220:223], a[156:159], v[20:23]
    v_cvt_pk_bf16_f32 v150, v52, v53
    v_mfma_f32_16x16x32_bf16 v[24:27], a[208:211], a[160:163], v[72:75]
    v_exp_f32 v59, v59
    v_mfma_f32_16x16x32_bf16 v[24:27], a[212:215], a[164:167], v[24:27]
    v_cvt_pk_bf16_f32 v151, v54, v55
    v_mfma_f32_16x16x32_bf16 v[24:27], a[216:219], a[168:171], v[24:27]
    v_exp_f32 v60, v60
    v_mfma_f32_16x16x32_bf16 v[24:27], a[220:223], a[172:175], v[24:27]
    v_cvt_pk_bf16_f32 v154, v56, v57
    v_mfma_f32_16x16x32_bf16 v[28:31], a[208:211], a[176:179], v[76:79]
    v_exp_f32 v61, v61
    v_mfma_f32_16x16x32_bf16 v[28:31], a[212:215], a[180:183], v[28:31]
    ds_read_b128 a[208:211], v165 offset:4096
    v_mfma_f32_16x16x32_bf16 v[28:31], a[216:219], a[184:187], v[28:31]
    v_exp_f32 v62, v62
    v_mfma_f32_16x16x32_bf16 v[28:31], a[220:223], a[188:191], v[28:31]
    s_waitcnt lgkmcnt(1)
    ds_read_b128 a[212:215], v165 offset:5120
    v_mfma_f32_16x16x32_bf16 v[32:35], a[192:195], a[128:131], v[64:67]
    v_exp_f32 v63, v63
    v_mfma_f32_16x16x32_bf16 v[32:35], a[196:199], a[132:135], v[32:35]
    ds_read_b128 a[216:219], v165 offset:6144
    v_mfma_f32_16x16x32_bf16 v[32:35], a[200:203], a[136:139], v[32:35]
    v_exp_f32 v0, v0
    v_mfma_f32_16x16x32_bf16 v[32:35], a[204:207], a[140:143], v[32:35]
    ds_read_b128 a[220:223], v165 offset:7168
    v_mfma_f32_16x16x32_bf16 v[36:39], a[192:195], a[144:147], v[68:71]
    v_exp_f32 v1, v1
    v_mfma_f32_16x16x32_bf16 v[36:39], a[196:199], a[148:151], v[36:39]
    buffer_load_dwordx4 v168, s[4:7], s17 offen offset:1024 sc1 lds
    v_mfma_f32_16x16x32_bf16 v[36:39], a[200:203], a[152:155], v[36:39]
    v_exp_f32 v2, v2
    v_mfma_f32_16x16x32_bf16 v[36:39], a[204:207], a[156:159], v[36:39]
    v_cvt_pk_bf16_f32 v155, v58, v59
    v_mfma_f32_16x16x32_bf16 v[40:43], a[192:195], a[160:163], v[72:75]
    v_exp_f32 v3, v3
    v_mfma_f32_16x16x32_bf16 v[40:43], a[196:199], a[164:167], v[40:43]
    v_cvt_pk_bf16_f32 v158, v60, v61
    v_mfma_f32_16x16x32_bf16 v[40:43], a[200:203], a[168:171], v[40:43]
    v_exp_f32 v4, v4
    v_mfma_f32_16x16x32_bf16 v[40:43], a[204:207], a[172:175], v[40:43]
    v_cvt_pk_bf16_f32 v159, v62, v63
    v_mfma_f32_16x16x32_bf16 v[44:47], a[192:195], a[176:179], v[76:79]
    v_exp_f32 v5, v5
    v_mfma_f32_16x16x32_bf16 v[44:47], a[196:199], a[180:183], v[44:47]
    ds_read_b128 a[192:195], v165 offset:8192
    v_mfma_f32_16x16x32_bf16 v[44:47], a[200:203], a[184:187], v[44:47]
    s_waitcnt lgkmcnt(1)
    ds_read_b128 a[196:199], v165 offset:9216
    v_mfma_f32_16x16x32_bf16 v[44:47], a[204:207], a[188:191], v[44:47]
    ds_read_b128 a[200:203], v165 offset:10240
    v_mfma_f32_16x16x32_bf16 v[48:51], a[208:211], a[128:131], v[64:67]
    v_exp_f32 v6, v6
    v_mfma_f32_16x16x32_bf16 v[48:51], a[212:215], a[132:135], v[48:51]
    ds_read_b128 a[204:207], v165 offset:11264
    v_mfma_f32_16x16x32_bf16 v[48:51], a[216:219], a[136:139], v[48:51]
    v_exp_f32 v7, v7
    v_mfma_f32_16x16x32_bf16 v[48:51], a[220:223], a[140:143], v[48:51]
    v_cvt_pk_bf16_f32 v96, v0, v1
    v_mfma_f32_16x16x32_bf16 v[52:55], a[208:211], a[144:147], v[68:71]
    v_exp_f32 v8, v8
    v_mfma_f32_16x16x32_bf16 v[52:55], a[212:215], a[148:151], v[52:55]
    buffer_load_dwordx4 v168, s[4:7], s17 offen offset:2048 sc1 lds
    v_mfma_f32_16x16x32_bf16 v[52:55], a[216:219], a[152:155], v[52:55]
    v_exp_f32 v9, v9
    v_mfma_f32_16x16x32_bf16 v[52:55], a[220:223], a[156:159], v[52:55]
    v_cvt_pk_bf16_f32 v97, v2, v3
    v_mfma_f32_16x16x32_bf16 v[56:59], a[208:211], a[160:163], v[72:75]
    v_exp_f32 v10, v10
    v_mfma_f32_16x16x32_bf16 v[56:59], a[212:215], a[164:167], v[56:59]
    v_cvt_pk_bf16_f32 v100, v4, v5
    v_mfma_f32_16x16x32_bf16 v[56:59], a[216:219], a[168:171], v[56:59]
    v_exp_f32 v11, v11
    v_mfma_f32_16x16x32_bf16 v[56:59], a[220:223], a[172:175], v[56:59]
    v_cvt_pk_bf16_f32 v101, v6, v7
    v_mfma_f32_16x16x32_bf16 v[60:63], a[208:211], a[176:179], v[76:79]
    v_exp_f32 v12, v12
    v_mfma_f32_16x16x32_bf16 v[60:63], a[212:215], a[180:183], v[60:63]
    ds_read_b128 a[208:211], v165 offset:12288
    v_mfma_f32_16x16x32_bf16 v[60:63], a[216:219], a[184:187], v[60:63]
    v_exp_f32 v13, v13
    v_mfma_f32_16x16x32_bf16 v[60:63], a[220:223], a[188:191], v[60:63]
    ds_read_b128 a[212:215], v165 offset:13312
    v_mfma_f32_16x16x32_bf16 a[224:227], a[240:243], v[128:131], a[224:227]
    v_exp_f32 v14, v14
    v_mfma_f32_16x16x32_bf16 a[224:227], a[240:243], v[144:147], a[224:227]
    ds_read_b128 a[216:219], v165 offset:14336
    v_mfma_f32_16x16x32_bf16 a[228:231], a[240:243], v[132:135], a[228:231]
    v_exp_f32 v15, v15
    v_mfma_f32_16x16x32_bf16 a[228:231], a[240:243], v[148:151], a[228:231]
    ds_read_b128 a[220:223], v165 offset:15360
    v_mfma_f32_16x16x32_bf16 a[232:235], a[240:243], v[136:139], a[232:235]
    v_exp_f32 v16, v16
    v_mfma_f32_16x16x32_bf16 a[232:235], a[240:243], v[152:155], a[232:235]
    buffer_load_dwordx4 v168, s[4:7], s17 offen offset:3072 sc1 lds
    v_mfma_f32_16x16x32_bf16 a[236:239], a[240:243], v[140:143], a[236:239]
    v_exp_f32 v17, v17
    v_mfma_f32_16x16x32_bf16 a[236:239], a[240:243], v[156:159], a[236:239]
    s_waitcnt lgkmcnt(1)
    v_cvt_pk_bf16_f32 v104, v8, v9
    v_mfma_f32_16x16x32_bf16 a[0:3], a[192:195], v[128:131], a[0:3]
    v_exp_f32 v18, v18
    v_mfma_f32_16x16x32_bf16 a[0:3], a[196:199], v[144:147], a[0:3]
    v_cvt_pk_bf16_f32 v105, v10, v11
    s_add_u32 m0, s19, 0x1000
    v_mfma_f32_16x16x32_bf16 a[32:35], a[192:195], v[132:135], a[32:35]
    v_exp_f32 v19, v19
    v_mfma_f32_16x16x32_bf16 a[32:35], a[196:199], v[148:151], a[32:35]
    v_cvt_pk_bf16_f32 v108, v12, v13
    v_mfma_f32_16x16x32_bf16 a[64:67], a[192:195], v[136:139], a[64:67]
    v_exp_f32 v20, v20
    v_mfma_f32_16x16x32_bf16 a[64:67], a[196:199], v[152:155], a[64:67]
    v_cvt_pk_bf16_f32 v109, v14, v15
    v_mfma_f32_16x16x32_bf16 a[96:99], a[192:195], v[140:143], a[96:99]
    v_exp_f32 v21, v21
    v_mfma_f32_16x16x32_bf16 a[96:99], a[196:199], v[156:159], a[96:99]
    ds_read_b128 a[192:195], v165 offset:16384
    v_mfma_f32_16x16x32_bf16 a[4:7], a[200:203], v[128:131], a[4:7]
    v_exp_f32 v22, v22
    v_mfma_f32_16x16x32_bf16 a[4:7], a[204:207], v[144:147], a[4:7]
    ds_read_b128 a[196:199], v165 offset:17408
    v_mfma_f32_16x16x32_bf16 a[36:39], a[200:203], v[132:135], a[36:39]
    v_exp_f32 v23, v23
    v_mfma_f32_16x16x32_bf16 a[36:39], a[204:207], v[148:151], a[36:39]
    v_cvt_pk_bf16_f32 v98, v16, v17
    v_mfma_f32_16x16x32_bf16 a[68:71], a[200:203], v[136:139], a[68:71]
    v_exp_f32 v24, v24
    v_mfma_f32_16x16x32_bf16 a[68:71], a[204:207], v[152:155], a[68:71]
    buffer_load_dwordx4 v169, s[4:7], s17 offen offset:0 sc1 lds
    v_mfma_f32_16x16x32_bf16 a[100:103], a[200:203], v[140:143], a[100:103]
    v_exp_f32 v25, v25
    v_mfma_f32_16x16x32_bf16 a[100:103], a[204:207], v[156:159], a[100:103]
    ds_read_b128 a[200:203], v165 offset:18432
    v_mfma_f32_16x16x32_bf16 a[8:11], a[208:211], v[128:131], a[8:11]
    v_exp_f32 v26, v26
    v_mfma_f32_16x16x32_bf16 a[8:11], a[212:215], v[144:147], a[8:11]
    ds_read_b128 a[204:207], v165 offset:19456
    v_mfma_f32_16x16x32_bf16 a[40:43], a[208:211], v[132:135], a[40:43]
    v_cvt_pk_bf16_f32 v99, v18, v19
    v_mfma_f32_16x16x32_bf16 a[40:43], a[212:215], v[148:151], a[40:43]
    v_cvt_pk_bf16_f32 v102, v20, v21
    v_mfma_f32_16x16x32_bf16 a[72:75], a[208:211], v[136:139], a[72:75]
    v_exp_f32 v27, v27
    v_mfma_f32_16x16x32_bf16 a[72:75], a[212:215], v[152:155], a[72:75]
    v_cvt_pk_bf16_f32 v103, v22, v23
    v_mfma_f32_16x16x32_bf16 a[104:107], a[208:211], v[140:143], a[104:107]
    v_exp_f32 v28, v28
    v_mfma_f32_16x16x32_bf16 a[104:107], a[212:215], v[156:159], a[104:107]
    s_waitcnt lgkmcnt(0)
    ds_read_b128 a[208:211], v165 offset:20480
    v_mfma_f32_16x16x32_bf16 a[12:15], a[216:219], v[128:131], a[12:15]
    v_exp_f32 v29, v29
    v_mfma_f32_16x16x32_bf16 a[12:15], a[220:223], v[144:147], a[12:15]
    ds_read_b128 a[212:215], v165 offset:21504
    v_mfma_f32_16x16x32_bf16 a[44:47], a[216:219], v[132:135], a[44:47]
    v_exp_f32 v30, v30
    v_mfma_f32_16x16x32_bf16 a[44:47], a[220:223], v[148:151], a[44:47]
    v_cvt_pk_bf16_f32 v106, v24, v25
    v_mfma_f32_16x16x32_bf16 a[76:79], a[216:219], v[136:139], a[76:79]
    v_exp_f32 v31, v31
    v_mfma_f32_16x16x32_bf16 a[76:79], a[220:223], v[152:155], a[76:79]
    buffer_load_dwordx4 v169, s[4:7], s17 offen offset:1024 sc1 lds
    v_mfma_f32_16x16x32_bf16 a[108:111], a[216:219], v[140:143], a[108:111]
    v_exp_f32 v32, v32
    v_mfma_f32_16x16x32_bf16 a[108:111], a[220:223], v[156:159], a[108:111]
    ds_read_b128 a[216:219], v165 offset:22528
    v_mfma_f32_16x16x32_bf16 a[16:19], a[192:195], v[128:131], a[16:19]
    v_exp_f32 v33, v33
    v_mfma_f32_16x16x32_bf16 a[16:19], a[196:199], v[144:147], a[16:19]
    ds_read_b128 a[220:223], v165 offset:23552
    v_mfma_f32_16x16x32_bf16 a[48:51], a[192:195], v[132:135], a[48:51]
    v_exp_f32 v34, v34
    v_mfma_f32_16x16x32_bf16 a[48:51], a[196:199], v[148:151], a[48:51]
    v_cvt_pk_bf16_f32 v107, v26, v27
    v_mfma_f32_16x16x32_bf16 a[80:83], a[192:195], v[136:139], a[80:83]
    v_exp_f32 v35, v35
    v_mfma_f32_16x16x32_bf16 a[80:83], a[196:199], v[152:155], a[80:83]
    v_cvt_pk_bf16_f32 v110, v28, v29
    v_mfma_f32_16x16x32_bf16 a[112:115], a[192:195], v[140:143], a[112:115]
    v_exp_f32 v36, v36
    v_mfma_f32_16x16x32_bf16 a[112:115], a[196:199], v[156:159], a[112:115]
    ds_read_b128 a[192:195], v165 offset:24576
    v_mfma_f32_16x16x32_bf16 a[20:23], a[200:203], v[128:131], a[20:23]
    v_exp_f32 v37, v37
    v_mfma_f32_16x16x32_bf16 a[20:23], a[204:207], v[144:147], a[20:23]
    ds_read_b128 a[196:199], v165 offset:25600
    v_mfma_f32_16x16x32_bf16 a[52:55], a[200:203], v[132:135], a[52:55]
    v_exp_f32 v38, v38
    v_mfma_f32_16x16x32_bf16 a[52:55], a[204:207], v[148:151], a[52:55]
    v_cvt_pk_bf16_f32 v111, v30, v31
    v_mfma_f32_16x16x32_bf16 a[84:87], a[200:203], v[136:139], a[84:87]
    v_exp_f32 v39, v39
    v_mfma_f32_16x16x32_bf16 a[84:87], a[204:207], v[152:155], a[84:87]
    buffer_load_dwordx4 v169, s[4:7], s17 offen offset:2048 sc1 lds
    v_mfma_f32_16x16x32_bf16 a[116:119], a[200:203], v[140:143], a[116:119]
    v_exp_f32 v40, v40
    v_mfma_f32_16x16x32_bf16 a[116:119], a[204:207], v[156:159], a[116:119]
    s_waitcnt lgkmcnt(0)
    ds_read_b128 a[200:203], v165 offset:26624
    v_mfma_f32_16x16x32_bf16 a[24:27], a[208:211], v[128:131], a[24:27]
    v_exp_f32 v41, v41
    v_mfma_f32_16x16x32_bf16 a[24:27], a[212:215], v[144:147], a[24:27]
    ds_read_b128 a[204:207], v165 offset:27648
    v_cvt_pk_bf16_f32 v112, v32, v33
    v_mfma_f32_16x16x32_bf16 a[56:59], a[208:211], v[132:135], a[56:59]
    v_exp_f32 v42, v42
    v_mfma_f32_16x16x32_bf16 a[56:59], a[212:215], v[148:151], a[56:59]
    v_cvt_pk_bf16_f32 v113, v34, v35
    v_mfma_f32_16x16x32_bf16 a[88:91], a[208:211], v[136:139], a[88:91]
    v_exp_f32 v43, v43
    v_mfma_f32_16x16x32_bf16 a[88:91], a[212:215], v[152:155], a[88:91]
    v_cvt_pk_bf16_f32 v116, v36, v37
    v_mfma_f32_16x16x32_bf16 a[120:123], a[208:211], v[140:143], a[120:123]
    v_exp_f32 v44, v44
    v_mfma_f32_16x16x32_bf16 a[120:123], a[212:215], v[156:159], a[120:123]
    ds_read_b128 a[208:211], v165 offset:28672
    v_mfma_f32_16x16x32_bf16 a[28:31], a[216:219], v[128:131], a[28:31]
    v_exp_f32 v45, v45
    v_mfma_f32_16x16x32_bf16 a[28:31], a[220:223], v[144:147], a[28:31]
    ds_read_b128 a[212:215], v165 offset:29696
    v_mfma_f32_16x16x32_bf16 a[60:63], a[216:219], v[132:135], a[60:63]
    v_exp_f32 v46, v46
    v_mfma_f32_16x16x32_bf16 a[60:63], a[220:223], v[148:151], a[60:63]
    buffer_load_dwordx4 v169, s[4:7], s17 offen offset:3072 sc1 lds
    v_mfma_f32_16x16x32_bf16 a[92:95], a[216:219], v[136:139], a[92:95]
    v_exp_f32 v47, v47
    v_mfma_f32_16x16x32_bf16 a[92:95], a[220:223], v[152:155], a[92:95]
    v_cvt_pk_bf16_f32 v117, v38, v39
    s_add_u32 s17, s17, 0x8000
    v_mfma_f32_16x16x32_bf16 a[124:127], a[216:219], v[140:143], a[124:127]
    ds_read_b128 a[216:219], v165 offset:30720
    s_and_b32 s17, s17, 0xfffff
    v_mfma_f32_16x16x32_bf16 a[124:127], a[220:223], v[156:159], a[124:127]
    ds_read_b128 a[220:223], v165 offset:31744
    s_add_u32 s19, s19, 0x8000
    s_and_b32 s19, s19, 0x1ffff
    s_sub_u32 s16, s16, 1
    s_cmp_lg_u32 s16, 0
    s_cbranch_scc1 L_loop
    v_mfma_f32_16x16x32_bf16 v[0:3], a[192:195], a[128:131], v[64:67]
    v_exp_f32 v48, v48
    v_mfma_f32_16x16x32_bf16 v[0:3], a[196:199], a[132:135], v[0:3]
    s_waitcnt lgkmcnt(2)
    v_cvt_pk_bf16_f32 v120, v40, v41
    v_mfma_f32_16x16x32_bf16 v[0:3], a[200:203], a[136:139], v[0:3]
    v_exp_f32 v49, v49
    v_mfma_f32_16x16x32_bf16 v[0:3], a[204:207], a[140:143], v[0:3]
    v_cvt_pk_bf16_f32 v121, v42, v43
    v_mfma_f32_16x16x32_bf16 v[4:7], a[192:195], a[144:147], v[68:71]
    v_exp_f32 v50, v50
    v_mfma_f32_16x16x32_bf16 v[4:7], a[196:199], a[148:151], v[4:7]
    v_cvt_pk_bf16_f32 v124, v44, v45
    v_mfma_f32_16x16x32_bf16 v[4:7], a[200:203], a[152:155], v[4:7]
    v_exp_f32 v51, v51
    v_mfma_f32_16x16x32_bf16 v[4:7], a[204:207], a[156:159], v[4:7]
    v_cvt_pk_bf16_f32 v125, v46, v47
    v_mfma_f32_16x16x32_bf16 v[8:11], a[192:195], a[160:163], v[72:75]
    v_exp_f32 v52, v52
    v_mfma_f32_16x16x32_bf16 v[8:11], a[196:199], a[164:167], v[8:11]
    v_cvt_pk_bf16_f32 v114, v48, v49
    v_mfma_f32_16x16x32_bf16 v[8:11], a[200:203], a[168:171], v[8:11]
    v_cvt_pk_bf16_f32 v115, v50, v51
    v_mfma_f32_16x16x32_bf16 v[8:11], a[204:207], a[172:175], v[8:11]
    s_waitcnt vmcnt(16) lgkmcnt(0)
    s_barrier
    v_mfma_f32_16x16x32_bf16 v[12:15], a[192:195], a[176:179], v[76:79]
    v_exp_f32 v53, v53
    v_mfma_f32_16x16x32_bf16 v[12:15], a[196:199], a[180:183], v[12:15]
    ds_read_b128 a[192:195], v165 offset:32768
    v_mfma_f32_16x16x32_bf16 v[12:15], a[200:203], a[184:187], v[12:15]
    v_exp_f32 v54, v54
    v_mfma_f32_16x16x32_bf16 v[12:15], a[204:207], a[188:191], v[12:15]
    ds_read_b128 a[196:199], v165 offset:33792
    v_mfma_f32_16x16x32_bf16 v[16:19], a[208:211], a[128:131], v[64:67]
    v_exp_f32 v55, v55
    v_mfma_f32_16x16x32_bf16 v[16:19], a[212:215], a[132:135], v[16:19]
    ds_read_b128 a[200:203], v165 offset:34816
    v_mfma_f32_16x16x32_bf16 v[16:19], a[216:219], a[136:139], v[16:19]
    v_exp_f32 v56, v56
    v_mfma_f32_16x16x32_bf16 v[16:19], a[220:223], a[140:143], v[16:19]
    ds_read_b128 a[204:207], v165 offset:35840
    v_mfma_f32_16x16x32_bf16 v[20:23], a[208:211], a[144:147], v[68:71]
    v_exp_f32 v57, v57
    v_mfma_f32_16x16x32_bf16 v[20:23], a[212:215], a[148:151], v[20:23]
    v_cvt_pk_bf16_f32 v118, v52, v53
    v_mfma_f32_16x16x32_bf16 v[20:23], a[216:219], a[152:155], v[20:23]
    v_exp_f32 v58, v58
    v_mfma_f32_16x16x32_bf16 v[20:23], a[220:223], a[156:159], v[20:23]
    v_cvt_pk_bf16_f32 v119, v54, v55
    v_mfma_f32_16x16x32_bf16 v[24:27], a[208:211], a[160:163], v[72:75]
    v_exp_f32 v59, v59
    v_mfma_f32_16x16x32_bf16 v[24:27], a[212:215], a[164:167], v[24:27]
    v_cvt_pk_bf16_f32 v122, v56, v57
    v_mfma_f32_16x16x32_bf16 v[24:27], a[216:219], a[168:171], v[24:27]
    v_exp_f32 v60, v60
    v_mfma_f32_16x16x32_bf16 v[24:27], a[220:223], a[172:175], v[24:27]
    v_cvt_pk_bf16_f32 v123, v58, v59
    v_mfma_f32_16x16x32_bf16 v[28:31], a[208:211], a[176:179], v[76:79]
    v_exp_f32 v61, v61
    v_mfma_f32_16x16x32_bf16 v[28:31], a[212:215], a[180:183], v[28:31]
    ds_read_b128 a[208:211], v165 offset:36864
    v_mfma_f32_16x16x32_bf16 v[28:31], a[216:219], a[184:187], v[28:31]
    v_exp_f32 v62, v62
    v_mfma_f32_16x16x32_bf16 v[28:31], a[220:223], a[188:191], v[28:31]
    s_waitcnt lgkmcnt(1)
    ds_read_b128 a[212:215], v165 offset:37888
    v_mfma_f32_16x16x32_bf16 v[32:35], a[192:195], a[128:131], v[64:67]
    v_exp_f32 v63, v63
    v_mfma_f32_16x16x32_bf16 v[32:35], a[196:199], a[132:135], v[32:35]
    ds_read_b128 a[216:219], v165 offset:38912
    v_mfma_f32_16x16x32_bf16 v[32:35], a[200:203], a[136:139], v[32:35]
    v_exp_f32 v0, v0
    v_mfma_f32_16x16x32_bf16 v[32:35], a[204:207], a[140:143], v[32:35]
    ds_read_b128 a[220:223], v165 offset:39936
    v_mfma_f32_16x16x32_bf16 v[36:39], a[192:195], a[144:147], v[68:71]
    v_exp_f32 v1, v1
    v_mfma_f32_16x16x32_bf16 v[36:39], a[196:199], a[148:151], v[36:39]
    v_cvt_pk_bf16_f32 v126, v60, v61
    v_mfma_f32_16x16x32_bf16 v[36:39], a[200:203], a[152:155], v[36:39]
    v_exp_f32 v2, v2
    v_mfma_f32_16x16x32_bf16 v[36:39], a[204:207], a[156:159], v[36:39]
    v_cvt_pk_bf16_f32 v127, v62, v63
    v_mfma_f32_16x16x32_bf16 v[40:43], a[192:195], a[160:163], v[72:75]
    v_exp_f32 v3, v3
    v_mfma_f32_16x16x32_bf16 v[40:43], a[196:199], a[164:167], v[40:43]
    v_cvt_pk_bf16_f32 v128, v0, v1
    v_mfma_f32_16x16x32_bf16 v[40:43], a[200:203], a[168:171], v[40:43]
    v_exp_f32 v4, v4
    v_mfma_f32_16x16x32_bf16 v[40:43], a[204:207], a[172:175], v[40:43]
    v_cvt_pk_bf16_f32 v129, v2, v3
    v_mfma_f32_16x16x32_bf16 v[44:47], a[192:195], a[176:179], v[76:79]
    v_exp_f32 v5, v5
    v_mfma_f32_16x16x32_bf16 v[44:47], a[196:199], a[180:183], v[44:47]
    ds_read_b128 a[192:195], v165 offset:40960
    v_mfma_f32_16x16x32_bf16 v[44:47], a[200:203], a[184:187], v[44:47]
    s_waitcnt lgkmcnt(1)
    ds_read_b128 a[196:199], v165 offset:41984
    v_mfma_f32_16x16x32_bf16 v[44:47], a[204:207], a[188:191], v[44:47]
    ds_read_b128 a[200:203], v165 offset:43008
    v_mfma_f32_16x16x32_bf16 v[48:51], a[208:211], a[128:131], v[64:67]
    v_exp_f32 v6, v6
    v_mfma_f32_16x16x32_bf16 v[48:51], a[212:215], a[132:135], v[48:51]
    ds_read_b128 a[204:207], v165 offset:44032
    v_mfma_f32_16x16x32_bf16 v[48:51], a[216:219], a[136:139], v[48:51]
    v_exp_f32 v7, v7
    v_mfma_f32_16x16x32_bf16 v[48:51], a[220:223], a[140:143], v[48:51]
    v_cvt_pk_bf16_f32 v132, v4, v5
    v_mfma_f32_16x16x32_bf16 v[52:55], a[208:211], a[144:147], v[68:71]
    v_exp_f32 v8, v8
    v_mfma_f32_16x16x32_bf16 v[52:55], a[212:215], a[148:151], v[52:55]
    v_cvt_pk_bf16_f32 v133, v6, v7
    v_mfma_f32_16x16x32_bf16 v[52:55], a[216:219], a[152:155], v[52:55]
    v_exp_f32 v9, v9
    v_mfma_f32_16x16x32_bf16 v[52:55], a[220:223], a[156:159], v[52:55]
    v_cvt_pk_bf16_f32 v136, v8, v9
    v_mfma_f32_16x16x32_bf16 v[56:59], a[208:211], a[160:163], v[72:75]
    v_exp_f32 v10, v10
    v_mfma_f32_16x16x32_bf16 v[56:59], a[212:215], a[164:167], v[56:59]
    v_mfma_f32_16x16x32_bf16 v[56:59], a[216:219], a[168:171], v[56:59]
    v_exp_f32 v11, v11
    v_mfma_f32_16x16x32_bf16 v[56:59], a[220:223], a[172:175], v[56:59]
    v_cvt_pk_bf16_f32 v137, v10, v11
    v_mfma_f32_16x16x32_bf16 v[60:63], a[208:211], a[176:179], v[76:79]
    v_exp_f32 v12, v12
    v_mfma_f32_16x16x32_bf16 v[60:63], a[212:215], a[180:183], v[60:63]
    ds_read_b128 a[208:211], v165 offset:45056
    v_mfma_f32_16x16x32_bf16 v[60:63], a[216:219], a[184:187], v[60:63]
    v_exp_f32 v13, v13
    v_mfma_f32_16x16x32_bf16 v[60:63], a[220:223], a[188:191], v[60:63]
    ds_read_b128 a[212:215], v165 offset:46080
    v_mfma_f32_16x16x32_bf16 a[224:227], a[240:243], v[96:99], a[224:227]
    v_exp_f32 v14, v14
    v_mfma_f32_16x16x32_bf16 a[224:227], a[240:243], v[112:115], a[224:227]
    ds_read_b128 a[216:219], v165 offset:47104
    v_mfma_f32_16x16x32_bf16 a[228:231], a[240:243], v[100:103], a[228:231]
    v_exp_f32 v15, v15
    v_mfma_f32_16x16x32_bf16 a[228:231], a[240:243], v[116:119], a[228:231]
    ds_read_b128 a[220:223], v165 offset:48128
    v_mfma_f32_16x16x32_bf16 a[232:235], a[240:243], v[104:107], a[232:235]
    v_exp_f32 v16, v16
    v_mfma_f32_16x16x32_bf16 a[232:235], a[240:243], v[120:123], a[232:235]
    v_cvt_pk_bf16_f32 v140, v12, v13
    v_mfma_f32_16x16x32_bf16 a[236:239], a[240:243], v[108:111], a[236:239]
    v_exp_f32 v17, v17
    v_mfma_f32_16x16x32_bf16 a[236:239], a[240:243], v[124:127], a[236:239]
    s_waitcnt lgkmcnt(1)
    v_cvt_pk_bf16_f32 v141, v14, v15
    v_mfma_f32_16x16x32_bf16 a[0:3], a[192:195], v[96:99], a[0:3]
    v_exp_f32 v18, v18
    v_mfma_f32_16x16x32_bf16 a[0:3], a[196:199], v[112:115], a[0:3]
    v_cvt_pk_bf16_f32 v130, v16, v17
    v_mfma_f32_16x16x32_bf16 a[32:35], a[192:195], v[100:103], a[32:35]
    v_exp_f32 v19, v19
    v_mfma_f32_16x16x32_bf16 a[32:35], a[196:199], v[116:119], a[32:35]
    v_cvt_pk_bf16_f32 v131, v18, v19
    v_mfma_f32_16x16x32_bf16 a[64:67], a[192:195], v[104:107], a[64:67]
    v_exp_f32 v20, v20
    v_mfma_f32_16x16x32_bf16 a[64:67], a[196:199], v[120:123], a[64:67]
    v_mfma_f32_16x16x32_bf16 a[96:99], a[192:195], v[108:111], a[96:99]
    v_exp_f32 v21, v21
    v_mfma_f32_16x16x32_bf16 a[96:99], a[196:199], v[124:127], a[96:99]
    ds_read_b128 a[192:195], v165 offset:49152
    v_mfma_f32_16x16x32_bf16 a[4:7], a[200:203], v[96:99], a[4:7]
    v_exp_f32 v22, v22
    v_mfma_f32_16x16x32_bf16 a[4:7], a[204:207], v[112:115], a[4:7]
    ds_read_b128 a[196:199], v165 offset:50176
    v_mfma_f32_16x16x32_bf16 a[36:39], a[200:203], v[100:103], a[36:39]
    v_exp_f32 v23, v23
    v_mfma_f32_16x16x32_bf16 a[36:39], a[204:207], v[116:119], a[36:39]
    v_cvt_pk_bf16_f32 v134, v20, v21
    v_mfma_f32_16x16x32_bf16 a[68:71], a[200:203], v[104:107], a[68:71]
    v_exp_f32 v24, v24
    v_mfma_f32_16x16x32_bf16 a[68:71], a[204:207], v[120:123], a[68:71]
    v_cvt_pk_bf16_f32 v135, v22, v23
    v_mfma_f32_16x16x32_bf16 a[100:103], a[200:203], v[108:111], a[100:103]
    v_exp_f32 v25, v25
    v_mfma_f32_16x16x32_bf16 a[100:103], a[204:207], v[124:127], a[100:103]
    ds_read_b128 a[200:203], v165 offset:51200
    v_mfma_f32_16x16x32_bf16 a[8:11], a[208:211], v[96:99], a[8:11]
    v_exp_f32 v26, v26
    v_mfma_f32_16x16x32_bf16 a[8:11], a[212:215], v[112:115], a[8:11]
    ds_read_b128 a[204:207], v165 offset:52224
    v_mfma_f32_16x16x32_bf16 a[40:43], a[208:211], v[100:103], a[40:43]
    v_cvt_pk_bf16_f32 v138, v24, v25
    v_mfma_f32_16x16x32_bf16 a[40:43], a[212:215], v[116:119], a[40:43]
    v_mfma_f32_16x16x32_bf16 a[72:75], a[208:211], v[104:107], a[72:75]
    v_exp_f32 v27, v27
    v_mfma_f32_16x16x32_bf16 a[72:75], a[212:215], v[120:123], a[72:75]
    v_cvt_pk_bf16_f32 v139, v26, v27
    v_mfma_f32_16x16x32_bf16 a[104:107], a[208:211], v[108:111], a[104:107]
    v_exp_f32 v28, v28
    v_mfma_f32_16x16x32_bf16 a[104:107], a[212:215], v[124:127], a[104:107]
    s_waitcnt lgkmcnt(0)
    ds_read_b128 a[208:211], v165 offset:53248
    v_mfma_f32_16x16x32_bf16 a[12:15], a[216:219], v[96:99], a[12:15]
    v_exp_f32 v29, v29
    v_mfma_f32_16x16x32_bf16 a[12:15], a[220:223], v[112:115], a[12:15]
    ds_read_b128 a[212:215], v165 offset:54272
    v_mfma_f32_16x16x32_bf16 a[44:47], a[216:219], v[100:103], a[44:47]
    v_exp_f32 v30, v30
    v_mfma_f32_16x16x32_bf16 a[44:47], a[220:223], v[116:119], a[44:47]
    v_cvt_pk_bf16_f32 v142, v28, v29
    v_mfma_f32_16x16x32_bf16 a[76:79], a[216:219], v[104:107], a[76:79]
    v_exp_f32 v31, v31
    v_mfma_f32_16x16x32_bf16 a[76:79], a[220:223], v[120:123], a[76:79]
    v_cvt_pk_bf16_f32 v143, v30, v31
    v_mfma_f32_16x16x32_bf16 a[108:111], a[216:219], v[108:111], a[108:111]
    v_exp_f32 v32, v32
    v_mfma_f32_16x16x32_bf16 a[108:111], a[220:223], v[124:127], a[108:111]
    ds_read_b128 a[216:219], v165 offset:55296
    v_mfma_f32_16x16x32_bf16 a[16:19], a[192:195], v[96:99], a[16:19]
    v_exp_f32 v33, v33
    v_mfma_f32_16x16x32_bf16 a[16:19], a[196:199], v[112:115], a[16:19]
    ds_read_b128 a[220:223], v165 offset:56320
    v_mfma_f32_16x16x32_bf16 a[48:51], a[192:195], v[100:103], a[48:51]
    v_exp_f32 v34, v34
    v_mfma_f32_16x16x32_bf16 a[48:51], a[196:199], v[116:119], a[48:51]
    v_cvt_pk_bf16_f32 v144, v32, v33
    v_mfma_f32_16x16x32_bf16 a[80:83], a[192:195], v[104:107], a[80:83]
    v_exp_f32 v35, v35
    v_mfma_f32_16x16x32_bf16 a[80:83], a[196:199], v[120:123], a[80:83]
    v_cvt_pk_bf16_f32 v145, v34, v35
    v_mfma_f32_16x16x32_bf16 a[112:115], a[192:195], v[108:111], a[112:115]
    v_exp_f32 v36, v36
    v_mfma_f32_16x16x32_bf16 a[112:115], a[196:199], v[124:127], a[112:115]
    ds_read_b128 a[192:195], v165 offset:57344
    v_mfma_f32_16x16x32_bf16 a[20:23], a[200:203], v[96:99], a[20:23]
    v_exp_f32 v37, v37
    v_mfma_f32_16x16x32_bf16 a[20:23], a[204:207], v[112:115], a[20:23]
    ds_read_b128 a[196:199], v165 offset:58368
    v_mfma_f32_16x16x32_bf16 a[52:55], a[200:203], v[100:103], a[52:55]
    v_exp_f32 v38, v38
    v_mfma_f32_16x16x32_bf16 a[52:55], a[204:207], v[116:119], a[52:55]
    v_cvt_pk_bf16_f32 v148, v36, v37
    v_mfma_f32_16x16x32_bf16 a[84:87], a[200:203], v[104:107], a[84:87]
    v_exp_f32 v39, v39
    v_mfma_f32_16x16x32_bf16 a[84:87], a[204:207], v[120:123], a[84:87]
    v_cvt_pk_bf16_f32 v149, v38, v39
    v_mfma_f32_16x16x32_bf16 a[116:119], a[200:203], v[108:111], a[116:119]
    v_exp_f32 v40, v40
    v_mfma_f32_16x16x32_bf16 a[116:119], a[204:207], v[124:127], a[116:119]
    s_waitcnt lgkmcnt(0)
    ds_read_b128 a[200:203], v165 offset:59392
    v_mfma_f32_16x16x32_bf16 a[24:27], a[208:211], v[96:99], a[24:27]
    v_exp_f32 v41, v41
    v_mfma_f32_16x16x32_bf16 a[24:27], a[212:215], v[112:115], a[24:27]
    ds_read_b128 a[204:207], v165 offset:60416
    v_mfma_f32_16x16x32_bf16 a[56:59], a[208:211], v[100:103], a[56:59]
    v_exp_f32 v42, v42
    v_mfma_f32_16x16x32_bf16 a[56:59], a[212:215], v[116:119], a[56:59]
    v_cvt_pk_bf16_f32 v152, v40, v41
    v_mfma_f32_16x16x32_bf16 a[88:91], a[208:211], v[104:107], a[88:91]
    v_exp_f32 v43, v43
    v_mfma_f32_16x16x32_bf16 a[88:91], a[212:215], v[120:123], a[88:91]
    v_cvt_pk_bf16_f32 v153, v42, v43
    v_mfma_f32_16x16x32_bf16 a[120:123], a[208:211], v[108:111], a[120:123]
    v_exp_f32 v44, v44
    v_mfma_f32_16x16x32_bf16 a[120:123], a[212:215], v[124:127], a[120:123]
    ds_read_b128 a[208:211], v165 offset:61440
    v_mfma_f32_16x16x32_bf16 a[28:31], a[216:219], v[96:99], a[28:31]
    v_exp_f32 v45, v45
    v_mfma_f32_16x16x32_bf16 a[28:31], a[220:223], v[112:115], a[28:31]
    ds_read_b128 a[212:215], v165 offset:62464
    v_mfma_f32_16x16x32_bf16 a[60:63], a[216:219], v[100:103], a[60:63]
    v_exp_f32 v46, v46
    v_mfma_f32_16x16x32_bf16 a[60:63], a[220:223], v[116:119], a[60:63]
    v_cvt_pk_bf16_f32 v156, v44, v45
    v_mfma_f32_16x16x32_bf16 a[92:95], a[216:219], v[104:107], a[92:95]
    v_exp_f32 v47, v47
    v_mfma_f32_16x16x32_bf16 a[92:95], a[220:223], v[120:123], a[92:95]
    v_cvt_pk_bf16_f32 v157, v46, v47
    v_mfma_f32_16x16x32_bf16 a[124:127], a[216:219], v[108:111], a[124:127]
    ds_read_b128 a[216:219], v165 offset:63488
    v_mfma_f32_16x16x32_bf16 a[124:127], a[220:223], v[124:127], a[124:127]
    ds_read_b128 a[220:223], v165 offset:64512
    v_xor_b32 v165, 0x10000, v165
    s_waitcnt vmcnt(0) lgkmcnt(0)
    s_barrier
    ds_read_b128 a[192:195], v165 offset:8192
    ds_read_b128 a[196:199], v165 offset:10240
    ds_read_b128 a[200:203], v165 offset:12288
    ds_read_b128 a[204:207], v165 offset:14336
    ds_read_b128 a[208:211], v165 offset:16384
    ds_read_b128 a[212:215], v165 offset:18432
    ds_read_b128 a[216:219], v165 offset:20480
    ds_read_b128 a[220:223], v165 offset:22528
    v_exp_f32 v48, v48
    v_exp_f32 v49, v49
    v_exp_f32 v50, v50
    v_cvt_pk_bf16_f32 v146, v48, v49
    s_waitcnt lgkmcnt(0)
    v_mfma_f32_16x16x32_bf16 a[0:3], a[192:195], v[128:131], a[0:3]
    v_exp_f32 v51, v51
    v_mfma_f32_16x16x32_bf16 a[32:35], a[192:195], v[132:135], a[32:35]
    v_exp_f32 v52, v52
    v_mfma_f32_16x16x32_bf16 a[64:67], a[192:195], v[136:139], a[64:67]
    v_cvt_pk_bf16_f32 v147, v50, v51
    v_mfma_f32_16x16x32_bf16 a[96:99], a[192:195], v[140:143], a[96:99]
    v_exp_f32 v53, v53
    ds_read_b128 a[192:195], v165 offset:9216
    v_mfma_f32_16x16x32_bf16 a[4:7], a[196:199], v[128:131], a[4:7]
    v_exp_f32 v54, v54
    v_mfma_f32_16x16x32_bf16 a[36:39], a[196:199], v[132:135], a[36:39]
    v_cvt_pk_bf16_f32 v150, v52, v53
    v_mfma_f32_16x16x32_bf16 a[68:71], a[196:199], v[136:139], a[68:71]
    v_exp_f32 v55, v55
    v_mfma_f32_16x16x32_bf16 a[100:103], a[196:199], v[140:143], a[100:103]
    v_exp_f32 v56, v56
    ds_read_b128 a[196:199], v165 offset:11264
    v_mfma_f32_16x16x32_bf16 a[8:11], a[200:203], v[128:131], a[8:11]
    v_cvt_pk_bf16_f32 v151, v54, v55
    v_mfma_f32_16x16x32_bf16 a[40:43], a[200:203], v[132:135], a[40:43]
    v_exp_f32 v57, v57
    v_mfma_f32_16x16x32_bf16 a[72:75], a[200:203], v[136:139], a[72:75]
    v_exp_f32 v58, v58
    v_mfma_f32_16x16x32_bf16 a[104:107], a[200:203], v[140:143], a[104:107]
    v_cvt_pk_bf16_f32 v154, v56, v57
    ds_read_b128 a[200:203], v165 offset:13312
    v_mfma_f32_16x16x32_bf16 a[12:15], a[204:207], v[128:131], a[12:15]
    v_exp_f32 v59, v59
    v_mfma_f32_16x16x32_bf16 a[44:47], a[204:207], v[132:135], a[44:47]
    v_exp_f32 v60, v60
    v_mfma_f32_16x16x32_bf16 a[76:79], a[204:207], v[136:139], a[76:79]
    v_cvt_pk_bf16_f32 v155, v58, v59
    v_mfma_f32_16x16x32_bf16 a[108:111], a[204:207], v[140:143], a[108:111]
    v_exp_f32 v61, v61
    ds_read_b128 a[204:207], v165 offset:15360
    v_mfma_f32_16x16x32_bf16 a[16:19], a[208:211], v[128:131], a[16:19]
    v_exp_f32 v62, v62
    v_mfma_f32_16x16x32_bf16 a[48:51], a[208:211], v[132:135], a[48:51]
    v_cvt_pk_bf16_f32 v158, v60, v61
    v_mfma_f32_16x16x32_bf16 a[80:83], a[208:211], v[136:139], a[80:83]
    v_exp_f32 v63, v63
    v_mfma_f32_16x16x32_bf16 a[112:115], a[208:211], v[140:143], a[112:115]
    s_nop 0
    ds_read_b128 a[208:211], v165 offset:17408
    v_mfma_f32_16x16x32_bf16 a[20:23], a[212:215], v[128:131], a[20:23]
    v_cvt_pk_bf16_f32 v159, v62, v63
    v_mfma_f32_16x16x32_bf16 a[52:55], a[212:215], v[132:135], a[52:55]
    v_mfma_f32_16x16x32_bf16 a[84:87], a[212:215], v[136:139], a[84:87]
    v_mfma_f32_16x16x32_bf16 a[116:119], a[212:215], v[140:143], a[116:119]
    ds_read_b128 a[212:215], v165 offset:19456
    v_mfma_f32_16x16x32_bf16 a[24:27], a[216:219], v[128:131], a[24:27]
    v_mfma_f32_16x16x32_bf16 a[56:59], a[216:219], v[132:135], a[56:59]
    v_mfma_f32_16x16x32_bf16 a[88:91], a[216:219], v[136:139], a[88:91]
    v_mfma_f32_16x16x32_bf16 a[120:123], a[216:219], v[140:143], a[120:123]
    ds_read_b128 a[216:219], v165 offset:21504
    v_mfma_f32_16x16x32_bf16 a[28:31], a[220:223], v[128:131], a[28:31]
    v_mfma_f32_16x16x32_bf16 a[60:63], a[220:223], v[132:135], a[60:63]
    v_mfma_f32_16x16x32_bf16 a[92:95], a[220:223], v[136:139], a[92:95]
    v_mfma_f32_16x16x32_bf16 a[124:127], a[220:223], v[140:143], a[124:127]
    ds_read_b128 a[220:223], v165 offset:23552
    s_nop 1
    v_mfma_f32_16x16x32_bf16 a[224:227], a[240:243], v[128:131], a[224:227]
    v_mfma_f32_16x16x32_bf16 a[224:227], a[240:243], v[144:147], a[224:227]
    v_mfma_f32_16x16x32_bf16 a[228:231], a[240:243], v[132:135], a[228:231]
    v_mfma_f32_16x16x32_bf16 a[228:231], a[240:243], v[148:151], a[228:231]
    v_mfma_f32_16x16x32_bf16 a[232:235], a[240:243], v[136:139], a[232:235]
    v_mfma_f32_16x16x32_bf16 a[232:235], a[240:243], v[152:155], a[232:235]
    v_mfma_f32_16x16x32_bf16 a[236:239], a[240:243], v[140:143], a[236:239]
    v_mfma_f32_16x16x32_bf16 a[236:239], a[240:243], v[156:159], a[236:239]
    s_waitcnt lgkmcnt(2)
    v_mfma_f32_16x16x32_bf16 a[0:3], a[192:195], v[144:147], a[0:3]
    v_mfma_f32_16x16x32_bf16 a[32:35], a[192:195], v[148:151], a[32:35]
    v_mfma_f32_16x16x32_bf16 a[64:67], a[192:195], v[152:155], a[64:67]
    v_mfma_f32_16x16x32_bf16 a[96:99], a[192:195], v[156:159], a[96:99]
    s_nop 7
    s_mov_b32 s20, 0x71800000
    v_mov_b32 v72, 0
    v_mov_b32 v73, 0
    v_accvgpr_read_b32 v186, a224
    v_accvgpr_read_b32 v187, a228
    v_accvgpr_read_b32 v188, a232
    v_accvgpr_read_b32 v189, a236
    v_max3_f32 v170, v186, v187, v188
    v_max_f32 v170, v170, v189
    v_add_f32 v171, v186, v187
    v_mfma_f32_16x16x32_bf16 a[4:7], a[196:199], v[144:147], a[4:7]
    v_add_f32 v172, v188, v189
    v_cmp_nle_f32 s[40:41], v170, s20
    v_cmp_u_f32 s[42:43], v171, v172
    v_rcp_f32 v64, v186
    v_rcp_f32 v66, v187
    v_rcp_f32 v68, v188
    v_rcp_f32 v70, v189
    s_nop 0
    v_mov_b32 v65, v64
    v_mov_b32 v67, v66
    v_mfma_f32_16x16x32_bf16 a[36:39], a[196:199], v[148:151], a[36:39]
    v_mov_b32 v69, v68
    v_mov_b32 v71, v70
    v_mfma_f32_16x16x32_bf16 a[68:71], a[196:199], v[152:155], a[68:71]
    v_mfma_f32_16x16x32_bf16 a[100:103], a[196:199], v[156:159], a[100:103]
    v_mfma_f32_16x16x32_bf16 a[8:11], a[200:203], v[144:147], a[8:11]
    v_mfma_f32_16x16x32_bf16 a[40:43], a[200:203], v[148:151], a[40:43]
    v_mfma_f32_16x16x32_bf16 a[72:75], a[200:203], v[152:155], a[72:75]
    v_accvgpr_read_b32 v0, a0
    v_accvgpr_read_b32 v1, a1
    v_accvgpr_read_b32 v2, a2
    v_accvgpr_read_b32 v3, a3
    v_accvgpr_read_b32 v4, a4
    v_accvgpr_read_b32 v5, a5
    v_accvgpr_read_b32 v6, a6
    v_accvgpr_read_b32 v7, a7
    v_pk_mul_f32 v[0:1], v[0:1], v[64:65]
    v_pk_mul_f32 v[2:3], v[2:3], v[64:65]
    v_mfma_f32_16x16x32_bf16 a[104:107], a[200:203], v[156:159], a[104:107]
    v_pk_mul_f32 v[4:5], v[4:5], v[64:65]
    v_pk_mul_f32 v[6:7], v[6:7], v[64:65]
    v_pk_fma_f32 v[72:73], v[0:1], 0, v[72:73]
    v_pk_fma_f32 v[72:73], v[2:3], 0, v[72:73]
    v_pk_fma_f32 v[72:73], v[4:5], 0, v[72:73]
    v_pk_fma_f32 v[72:73], v[6:7], 0, v[72:73]
    v_cvt_pk_bf16_f32 v32, v0, v1
    v_cvt_pk_bf16_f32 v33, v2, v3
    v_cvt_pk_bf16_f32 v34, v4, v5
    v_cvt_pk_bf16_f32 v35, v6, v7
    v_mfma_f32_16x16x32_bf16 a[12:15], a[204:207], v[144:147], a[12:15]
    buffer_store_dwordx4 v[32:35], v180, s[12:15], s35 offen offset:0 nt
    v_accvgpr_read_b32 v8, a32
    v_accvgpr_read_b32 v9, a33
    v_accvgpr_read_b32 v10, a34
    v_accvgpr_read_b32 v11, a35
    v_accvgpr_read_b32 v12, a36
    v_accvgpr_read_b32 v13, a37
    v_accvgpr_read_b32 v14, a38
    v_accvgpr_read_b32 v15, a39
    v_pk_mul_f32 v[8:9], v[8:9], v[66:67]
    v_mfma_f32_16x16x32_bf16 a[44:47], a[204:207], v[148:151], a[44:47]
    v_pk_mul_f32 v[10:11], v[10:11], v[66:67]
    v_pk_mul_f32 v[12:13], v[12:13], v[66:67]
    v_pk_mul_f32 v[14:15], v[14:15], v[66:67]
    v_pk_fma_f32 v[72:73], v[8:9], 0, v[72:73]
    v_pk_fma_f32 v[72:73], v[10:11], 0, v[72:73]
    v_pk_fma_f32 v[72:73], v[12:13], 0, v[72:73]
    v_pk_fma_f32 v[72:73], v[14:15], 0, v[72:73]
    v_cvt_pk_bf16_f32 v36, v8, v9
    v_cvt_pk_bf16_f32 v37, v10, v11
    v_cvt_pk_bf16_f32 v38, v12, v13
    v_mfma_f32_16x16x32_bf16 a[76:79], a[204:207], v[152:155], a[76:79]
    v_cvt_pk_bf16_f32 v39, v14, v15
    buffer_store_dwordx4 v[36:39], v180, s[12:15], s36 offen offset:0 nt
    v_accvgpr_read_b32 v16, a64
    v_accvgpr_read_b32 v17, a65
    v_accvgpr_read_b32 v18, a66
    v_accvgpr_read_b32 v19, a67
    v_accvgpr_read_b32 v20, a68
    v_accvgpr_read_b32 v21, a69
    v_accvgpr_read_b32 v22, a70
    v_accvgpr_read_b32 v23, a71
    v_mfma_f32_16x16x32_bf16 a[108:111], a[204:207], v[156:159], a[108:111]
    v_pk_mul_f32 v[16:17], v[16:17], v[68:69]
    v_pk_mul_f32 v[18:19], v[18:19], v[68:69]
    v_pk_mul_f32 v[20:21], v[20:21], v[68:69]
    v_pk_mul_f32 v[22:23], v[22:23], v[68:69]
    v_pk_fma_f32 v[72:73], v[16:17], 0, v[72:73]
    v_pk_fma_f32 v[72:73], v[18:19], 0, v[72:73]
    v_pk_fma_f32 v[72:73], v[20:21], 0, v[72:73]
    v_pk_fma_f32 v[72:73], v[22:23], 0, v[72:73]
    v_cvt_pk_bf16_f32 v40, v16, v17
    v_cvt_pk_bf16_f32 v41, v18, v19
    v_mfma_f32_16x16x32_bf16 a[16:19], a[208:211], v[144:147], a[16:19]
    v_cvt_pk_bf16_f32 v42, v20, v21
    v_cvt_pk_bf16_f32 v43, v22, v23
    buffer_store_dwordx4 v[40:43], v180, s[12:15], s37 offen offset:0 nt
    v_accvgpr_read_b32 v24, a96
    v_accvgpr_read_b32 v25, a97
    v_accvgpr_read_b32 v26, a98
    v_accvgpr_read_b32 v27, a99
    v_accvgpr_read_b32 v28, a100
    v_accvgpr_read_b32 v29, a101
    v_accvgpr_read_b32 v30, a102
    v_mfma_f32_16x16x32_bf16 a[48:51], a[208:211], v[148:151], a[48:51]
    v_accvgpr_read_b32 v31, a103
    v_pk_mul_f32 v[24:25], v[24:25], v[70:71]
    v_pk_mul_f32 v[26:27], v[26:27], v[70:71]
    v_pk_mul_f32 v[28:29], v[28:29], v[70:71]
    v_pk_mul_f32 v[30:31], v[30:31], v[70:71]
    v_pk_fma_f32 v[72:73], v[24:25], 0, v[72:73]
    v_pk_fma_f32 v[72:73], v[26:27], 0, v[72:73]
    v_pk_fma_f32 v[72:73], v[28:29], 0, v[72:73]
    v_pk_fma_f32 v[72:73], v[30:31], 0, v[72:73]
    v_cvt_pk_bf16_f32 v44, v24, v25
    v_mfma_f32_16x16x32_bf16 a[80:83], a[208:211], v[152:155], a[80:83]
    v_cvt_pk_bf16_f32 v45, v26, v27
    v_cvt_pk_bf16_f32 v46, v28, v29
    v_cvt_pk_bf16_f32 v47, v30, v31
    buffer_store_dwordx4 v[44:47], v180, s[12:15], s38 offen offset:0 nt
    v_accvgpr_read_b32 v0, a8
    v_accvgpr_read_b32 v1, a9
    v_accvgpr_read_b32 v2, a10
    v_accvgpr_read_b32 v3, a11
    v_accvgpr_read_b32 v4, a12
    v_accvgpr_read_b32 v5, a13
    v_mfma_f32_16x16x32_bf16 a[112:115], a[208:211], v[156:159], a[112:115]
    v_accvgpr_read_b32 v6, a14
    v_accvgpr_read_b32 v7, a15
    v_pk_mul_f32 v[0:1], v[0:1], v[64:65]
    v_pk_mul_f32 v[2:3], v[2:3], v[64:65]
    v_pk_mul_f32 v[4:5], v[4:5], v[64:65]
    v_pk_mul_f32 v[6:7], v[6:7], v[64:65]
    v_pk_fma_f32 v[72:73], v[0:1], 0, v[72:73]
    v_pk_fma_f32 v[72:73], v[2:3], 0, v[72:73]
    v_pk_fma_f32 v[72:73], v[4:5], 0, v[72:73]
    v_pk_fma_f32 v[72:73], v[6:7], 0, v[72:73]
    v_mfma_f32_16x16x32_bf16 a[20:23], a[212:215], v[144:147], a[20:23]
    v_cvt_pk_bf16_f32 v32, v0, v1
    v_cvt_pk_bf16_f32 v33, v2, v3
    v_cvt_pk_bf16_f32 v34, v4, v5
    v_cvt_pk_bf16_f32 v35, v6, v7
    buffer_store_dwordx4 v[32:35], v180, s[12:15], s35 offen offset:64 nt
    v_accvgpr_read_b32 v8, a40
    v_accvgpr_read_b32 v9, a41
    v_accvgpr_read_b32 v10, a42
    v_accvgpr_read_b32 v11, a43
    v_accvgpr_read_b32 v12, a44
    v_mfma_f32_16x16x32_bf16 a[52:55], a[212:215], v[148:151], a[52:55]
    v_accvgpr_read_b32 v13, a45
    v_accvgpr_read_b32 v14, a46
    v_accvgpr_read_b32 v15, a47
    v_pk_mul_f32 v[8:9], v[8:9], v[66:67]
    v_pk_mul_f32 v[10:11], v[10:11], v[66:67]
    v_pk_mul_f32 v[12:13], v[12:13], v[66:67]
    v_pk_mul_f32 v[14:15], v[14:15], v[66:67]
    v_pk_fma_f32 v[72:73], v[8:9], 0, v[72:73]
    v_pk_fma_f32 v[72:73], v[10:11], 0, v[72:73]
    v_pk_fma_f32 v[72:73], v[12:13], 0, v[72:73]
    v_mfma_f32_16x16x32_bf16 a[84:87], a[212:215], v[152:155], a[84:87]
    v_pk_fma_f32 v[72:73], v[14:15], 0, v[72:73]
    v_cvt_pk_bf16_f32 v36, v8, v9
    v_cvt_pk_bf16_f32 v37, v10, v11
    v_cvt_pk_bf16_f32 v38, v12, v13
    v_cvt_pk_bf16_f32 v39, v14, v15
    buffer_store_dwordx4 v[36:39], v180, s[12:15], s36 offen offset:64 nt
    v_accvgpr_read_b32 v16, a72
    v_accvgpr_read_b32 v17, a73
    v_accvgpr_read_b32 v18, a74
    v_accvgpr_read_b32 v19, a75
    v_mfma_f32_16x16x32_bf16 a[116:119], a[212:215], v[156:159], a[116:119]
    v_accvgpr_read_b32 v20, a76
    v_accvgpr_read_b32 v21, a77
    v_accvgpr_read_b32 v22, a78
    v_accvgpr_read_b32 v23, a79
    v_pk_mul_f32 v[16:17], v[16:17], v[68:69]
    v_pk_mul_f32 v[18:19], v[18:19], v[68:69]
    v_pk_mul_f32 v[20:21], v[20:21], v[68:69]
    v_pk_mul_f32 v[22:23], v[22:23], v[68:69]
    v_pk_fma_f32 v[72:73], v[16:17], 0, v[72:73]
    v_pk_fma_f32 v[72:73], v[18:19], 0, v[72:73]
    s_waitcnt lgkmcnt(0)
    v_mfma_f32_16x16x32_bf16 a[24:27], a[216:219], v[144:147], a[24:27]
    v_pk_fma_f32 v[72:73], v[20:21], 0, v[72:73]
    v_pk_fma_f32 v[72:73], v[22:23], 0, v[72:73]
    v_cvt_pk_bf16_f32 v40, v16, v17
    v_cvt_pk_bf16_f32 v41, v18, v19
    v_cvt_pk_bf16_f32 v42, v20, v21
    v_cvt_pk_bf16_f32 v43, v22, v23
    buffer_store_dwordx4 v[40:43], v180, s[12:15], s37 offen offset:64 nt
    v_accvgpr_read_b32 v24, a104
    v_accvgpr_read_b32 v25, a105
    v_accvgpr_read_b32 v26, a106
    v_mfma_f32_16x16x32_bf16 a[56:59], a[216:219], v[148:151], a[56:59]
    v_accvgpr_read_b32 v27, a107
    v_accvgpr_read_b32 v28, a108
    v_accvgpr_read_b32 v29, a109
    v_accvgpr_read_b32 v30, a110
    v_accvgpr_read_b32 v31, a111
    v_pk_mul_f32 v[24:25], v[24:25], v[70:71]
    v_pk_mul_f32 v[26:27], v[26:27], v[70:71]
    v_pk_mul_f32 v[28:29], v[28:29], v[70:71]
    v_pk_mul_f32 v[30:31], v[30:31], v[70:71]
    v_pk_fma_f32 v[72:73], v[24:25], 0, v[72:73]
    v_mfma_f32_16x16x32_bf16 a[88:91], a[216:219], v[152:155], a[88:91]
    v_pk_fma_f32 v[72:73], v[26:27], 0, v[72:73]
    v_pk_fma_f32 v[72:73], v[28:29], 0, v[72:73]
    v_pk_fma_f32 v[72:73], v[30:31], 0, v[72:73]
    v_cvt_pk_bf16_f32 v44, v24, v25
    v_cvt_pk_bf16_f32 v45, v26, v27
    v_cvt_pk_bf16_f32 v46, v28, v29
    v_cvt_pk_bf16_f32 v47, v30, v31
    buffer_store_dwordx4 v[44:47], v180, s[12:15], s38 offen offset:64 nt
    v_accvgpr_read_b32 v0, a16
    v_accvgpr_read_b32 v1, a17
    v_mfma_f32_16x16x32_bf16 a[120:123], a[216:219], v[156:159], a[120:123]
    v_accvgpr_read_b32 v2, a18
    v_accvgpr_read_b32 v3, a19
    v_accvgpr_read_b32 v4, a20
    v_accvgpr_read_b32 v5, a21
    v_accvgpr_read_b32 v6, a22
    v_accvgpr_read_b32 v7, a23
    v_pk_mul_f32 v[0:1], v[0:1], v[64:65]
    v_pk_mul_f32 v[2:3], v[2:3], v[64:65]
    v_pk_mul_f32 v[4:5], v[4:5], v[64:65]
    v_pk_mul_f32 v[6:7], v[6:7], v[64:65]
    v_mfma_f32_16x16x32_bf16 a[28:31], a[220:223], v[144:147], a[28:31]
    v_pk_fma_f32 v[72:73], v[0:1], 0, v[72:73]
    v_pk_fma_f32 v[72:73], v[2:3], 0, v[72:73]
    v_pk_fma_f32 v[72:73], v[4:5], 0, v[72:73]
    v_pk_fma_f32 v[72:73], v[6:7], 0, v[72:73]
    v_cvt_pk_bf16_f32 v32, v0, v1
    v_cvt_pk_bf16_f32 v33, v2, v3
    v_cvt_pk_bf16_f32 v34, v4, v5
    v_cvt_pk_bf16_f32 v35, v6, v7
    buffer_store_dwordx4 v[32:35], v180, s[12:15], s35 offen offset:128 nt
    v_accvgpr_read_b32 v8, a48
    v_mfma_f32_16x16x32_bf16 a[60:63], a[220:223], v[148:151], a[60:63]
    v_accvgpr_read_b32 v9, a49
    v_accvgpr_read_b32 v10, a50
    v_accvgpr_read_b32 v11, a51
    v_accvgpr_read_b32 v12, a52
    v_accvgpr_read_b32 v13, a53
    v_accvgpr_read_b32 v14, a54
    v_accvgpr_read_b32 v15, a55
    v_pk_mul_f32 v[8:9], v[8:9], v[66:67]
    v_pk_mul_f32 v[10:11], v[10:11], v[66:67]
    v_pk_mul_f32 v[12:13], v[12:13], v[66:67]
    v_mfma_f32_16x16x32_bf16 a[92:95], a[220:223], v[152:155], a[92:95]
    v_pk_mul_f32 v[14:15], v[14:15], v[66:67]
    v_pk_fma_f32 v[72:73], v[8:9], 0, v[72:73]
    v_pk_fma_f32 v[72:73], v[10:11], 0, v[72:73]
    v_pk_fma_f32 v[72:73], v[12:13], 0, v[72:73]
    v_pk_fma_f32 v[72:73], v[14:15], 0, v[72:73]
    v_cvt_pk_bf16_f32 v36, v8, v9
    v_cvt_pk_bf16_f32 v37, v10, v11
    v_cvt_pk_bf16_f32 v38, v12, v13
    v_cvt_pk_bf16_f32 v39, v14, v15
    buffer_store_dwordx4 v[36:39], v180, s[12:15], s36 offen offset:128 nt
    v_mfma_f32_16x16x32_bf16 a[124:127], a[220:223], v[156:159], a[124:127]
    v_accvgpr_read_b32 v16, a80
    v_accvgpr_read_b32 v17, a81
    v_accvgpr_read_b32 v18, a82
    v_accvgpr_read_b32 v19, a83
    v_accvgpr_read_b32 v20, a84
    v_accvgpr_read_b32 v21, a85
    v_accvgpr_read_b32 v22, a86
    v_accvgpr_read_b32 v23, a87
    v_pk_mul_f32 v[16:17], v[16:17], v[68:69]
    v_pk_mul_f32 v[18:19], v[18:19], v[68:69]
    v_pk_mul_f32 v[20:21], v[20:21], v[68:69]
    v_pk_mul_f32 v[22:23], v[22:23], v[68:69]
    v_pk_fma_f32 v[72:73], v[16:17], 0, v[72:73]
    v_pk_fma_f32 v[72:73], v[18:19], 0, v[72:73]
    v_pk_fma_f32 v[72:73], v[20:21], 0, v[72:73]
    v_pk_fma_f32 v[72:73], v[22:23], 0, v[72:73]
    v_cvt_pk_bf16_f32 v40, v16, v17
    v_cvt_pk_bf16_f32 v41, v18, v19
    v_cvt_pk_bf16_f32 v42, v20, v21
    v_cvt_pk_bf16_f32 v43, v22, v23
    buffer_store_dwordx4 v[40:43], v180, s[12:15], s37 offen offset:128 nt
    v_accvgpr_read_b32 v24, a112
    v_accvgpr_read_b32 v25, a113
    v_accvgpr_read_b32 v26, a114
    v_accvgpr_read_b32 v27, a115
    v_accvgpr_read_b32 v28, a116
    v_accvgpr_read_b32 v29, a117
    v_accvgpr_read_b32 v30, a118
    v_accvgpr_read_b32 v31, a119
    v_pk_mul_f32 v[24:25], v[24:25], v[70:71]
    v_pk_mul_f32 v[26:27], v[26:27], v[70:71]
    v_pk_mul_f32 v[28:29], v[28:29], v[70:71]
    v_pk_mul_f32 v[30:31], v[30:31], v[70:71]
    v_pk_fma_f32 v[72:73], v[24:25], 0, v[72:73]
    v_pk_fma_f32 v[72:73], v[26:27], 0, v[72:73]
    v_pk_fma_f32 v[72:73], v[28:29], 0, v[72:73]
    v_pk_fma_f32 v[72:73], v[30:31], 0, v[72:73]
    v_cvt_pk_bf16_f32 v44, v24, v25
    v_cvt_pk_bf16_f32 v45, v26, v27
    v_cvt_pk_bf16_f32 v46, v28, v29
    v_cvt_pk_bf16_f32 v47, v30, v31
    buffer_store_dwordx4 v[44:47], v180, s[12:15], s38 offen offset:128 nt
    s_nop 7
    v_accvgpr_read_b32 v0, a24
    v_accvgpr_read_b32 v1, a25
    v_accvgpr_read_b32 v2, a26
    v_accvgpr_read_b32 v3, a27
    v_accvgpr_read_b32 v4, a28
    v_accvgpr_read_b32 v5, a29
    v_accvgpr_read_b32 v6, a30
    v_accvgpr_read_b32 v7, a31
    v_pk_mul_f32 v[0:1], v[0:1], v[64:65]
    v_pk_mul_f32 v[2:3], v[2:3], v[64:65]
    v_pk_mul_f32 v[4:5], v[4:5], v[64:65]
    v_pk_mul_f32 v[6:7], v[6:7], v[64:65]
    v_pk_fma_f32 v[72:73], v[0:1], 0, v[72:73]
    v_pk_fma_f32 v[72:73], v[2:3], 0, v[72:73]
    v_pk_fma_f32 v[72:73], v[4:5], 0, v[72:73]
    v_pk_fma_f32 v[72:73], v[6:7], 0, v[72:73]
    v_cvt_pk_bf16_f32 v32, v0, v1
    v_cvt_pk_bf16_f32 v33, v2, v3
    v_cvt_pk_bf16_f32 v34, v4, v5
    v_cvt_pk_bf16_f32 v35, v6, v7
    buffer_store_dwordx4 v[32:35], v180, s[12:15], s35 offen offset:192 nt
    v_accvgpr_read_b32 v8, a56
    v_accvgpr_read_b32 v9, a57
    v_accvgpr_read_b32 v10, a58
    v_accvgpr_read_b32 v11, a59
    v_accvgpr_read_b32 v12, a60
    v_accvgpr_read_b32 v13, a61
    v_accvgpr_read_b32 v14, a62
    v_accvgpr_read_b32 v15, a63
    v_pk_mul_f32 v[8:9], v[8:9], v[66:67]
    v_pk_mul_f32 v[10:11], v[10:11], v[66:67]
    v_pk_mul_f32 v[12:13], v[12:13], v[66:67]
    v_pk_mul_f32 v[14:15], v[14:15], v[66:67]
    v_pk_fma_f32 v[72:73], v[8:9], 0, v[72:73]
    v_pk_fma_f32 v[72:73], v[10:11], 0, v[72:73]
    v_pk_fma_f32 v[72:73], v[12:13], 0, v[72:73]
    v_pk_fma_f32 v[72:73], v[14:15], 0, v[72:73]
    v_cvt_pk_bf16_f32 v36, v8, v9
    v_cvt_pk_bf16_f32 v37, v10, v11
    v_cvt_pk_bf16_f32 v38, v12, v13
    v_cvt_pk_bf16_f32 v39, v14, v15
    buffer_store_dwordx4 v[36:39], v180, s[12:15], s36 offen offset:192 nt
    v_accvgpr_read_b32 v16, a88
    v_accvgpr_read_b32 v17, a89
    v_accvgpr_read_b32 v18, a90
    v_accvgpr_read_b32 v19, a91
    v_accvgpr_read_b32 v20, a92
    v_accvgpr_read_b32 v21, a93
    v_accvgpr_read_b32 v22, a94
    v_accvgpr_read_b32 v23, a95
    v_pk_mul_f32 v[16:17], v[16:17], v[68:69]
    v_pk_mul_f32 v[18:19], v[18:19], v[68:69]
    v_pk_mul_f32 v[20:21], v[20:21], v[68:69]
    v_pk_mul_f32 v[22:23], v[22:23], v[68:69]
    v_pk_fma_f32 v[72:73], v[16:17], 0, v[72:73]
    v_pk_fma_f32 v[72:73], v[18:19], 0, v[72:73]
    v_pk_fma_f32 v[72:73], v[20:21], 0, v[72:73]
    v_pk_fma_f32 v[72:73], v[22:23], 0, v[72:73]
    v_cvt_pk_bf16_f32 v40, v16, v17
    v_cvt_pk_bf16_f32 v41, v18, v19
    v_cvt_pk_bf16_f32 v42, v20, v21
    v_cvt_pk_bf16_f32 v43, v22, v23
    buffer_store_dwordx4 v[40:43], v180, s[12:15], s37 offen offset:192 nt
    v_accvgpr_read_b32 v24, a120
    v_accvgpr_read_b32 v25, a121
    v_accvgpr_read_b32 v26, a122
    v_accvgpr_read_b32 v27, a123
    v_accvgpr_read_b32 v28, a124
    v_accvgpr_read_b32 v29, a125
    v_accvgpr_read_b32 v30, a126
    v_accvgpr_read_b32 v31, a127
    v_pk_mul_f32 v[24:25], v[24:25], v[70:71]
    v_pk_mul_f32 v[26:27], v[26:27], v[70:71]
    v_pk_mul_f32 v[28:29], v[28:29], v[70:71]
    v_pk_mul_f32 v[30:31], v[30:31], v[70:71]
    v_pk_fma_f32 v[72:73], v[24:25], 0, v[72:73]
    v_pk_fma_f32 v[72:73], v[26:27], 0, v[72:73]
    v_pk_fma_f32 v[72:73], v[28:29], 0, v[72:73]
    v_pk_fma_f32 v[72:73], v[30:31], 0, v[72:73]
    v_cvt_pk_bf16_f32 v44, v24, v25
    v_cvt_pk_bf16_f32 v45, v26, v27
    v_cvt_pk_bf16_f32 v46, v28, v29
    v_cvt_pk_bf16_f32 v47, v30, v31
    buffer_store_dwordx4 v[44:47], v180, s[12:15], s38 offen offset:192 nt
    v_cmp_u_f32 vcc, v72, v73
    s_or_b64 s[40:41], s[40:41], s[42:43]
    s_or_b64 vcc, vcc, s[40:41]
    s_cbranch_vccnz L_fallback
    s_branch L_fin
L_epi:
    s_waitcnt vmcnt(0)
    s_nop 15
    s_mov_b32 s20, 0x71800000
    v_accvgpr_read_b32 v186, a224
    v_accvgpr_read_b32 v187, a228
    v_accvgpr_read_b32 v188, a232
    v_accvgpr_read_b32 v189, a236
    v_max3_f32 v170, v186, v187, v188
    v_max_f32 v170, v170, v189
    v_add_f32 v171, v186, v187
    v_add_f32 v172, v188, v189
    v_cmp_nle_f32 s[40:41], v170, s20
    v_cmp_u_f32 s[42:43], v171, v172
    v_rcp_f32 v186, v186
    v_rcp_f32 v187, v187
    v_rcp_f32 v188, v188
    v_rcp_f32 v189, v189
    v_mov_b32 v170, 0
    v_mov_b32 v171, 0
    v_accvgpr_read_b32 v64, a0
    v_accvgpr_read_b32 v65, a1
    v_mul_f32 v64, v64, v186
    v_mul_f32 v65, v65, v186
    v_fma_f32 v170, v64, 0, v170
    v_fma_f32 v171, v65, 0, v171
    v_cvt_pk_bf16_f32 v0, v64, v65
    v_accvgpr_read_b32 v66, a2
    v_accvgpr_read_b32 v67, a3
    v_mul_f32 v66, v66, v186
    v_mul_f32 v67, v67, v186
    v_fma_f32 v170, v66, 0, v170
    v_fma_f32 v171, v67, 0, v171
    v_cvt_pk_bf16_f32 v1, v66, v67
    v_accvgpr_read_b32 v68, a4
    v_accvgpr_read_b32 v69, a5
    v_mul_f32 v68, v68, v186
    v_mul_f32 v69, v69, v186
    v_fma_f32 v170, v68, 0, v170
    v_fma_f32 v171, v69, 0, v171
    v_cvt_pk_bf16_f32 v2, v68, v69
    v_accvgpr_read_b32 v70, a6
    v_accvgpr_read_b32 v71, a7
    v_mul_f32 v70, v70, v186
    v_mul_f32 v71, v71, v186
    v_fma_f32 v170, v70, 0, v170
    v_fma_f32 v171, v71, 0, v171
    v_cvt_pk_bf16_f32 v3, v70, v71
    v_accvgpr_read_b32 v64, a8
    v_accvgpr_read_b32 v65, a9
    v_mul_f32 v64, v64, v186
    v_mul_f32 v65, v65, v186
    v_fma_f32 v170, v64, 0, v170
    v_fma_f32 v171, v65, 0, v171
    v_cvt_pk_bf16_f32 v4, v64, v65
    v_accvgpr_read_b32 v66, a10
    v_accvgpr_read_b32 v67, a11
    v_mul_f32 v66, v66, v186
    v_mul_f32 v67, v67, v186
    v_fma_f32 v170, v66, 0, v170
    v_fma_f32 v171, v67, 0, v171
    v_cvt_pk_bf16_f32 v5, v66, v67
    v_accvgpr_read_b32 v68, a12
    v_accvgpr_read_b32 v69, a13
    v_mul_f32 v68, v68, v186
    v_mul_f32 v69, v69, v186
    v_fma_f32 v170, v68, 0, v170
    v_fma_f32 v171, v69, 0, v171
    v_cvt_pk_bf16_f32 v6, v68, v69
    v_accvgpr_read_b32 v70, a14
    v_accvgpr_read_b32 v71, a15
    v_mul_f32 v70, v70, v186
    v_mul_f32 v71, v71, v186
    v_fma_f32 v170, v70, 0, v170
    v_fma_f32 v171, v71, 0, v171
    v_cvt_pk_bf16_f32 v7, v70, v71
    v_accvgpr_read_b32 v64, a16
    v_accvgpr_read_b32 v65, a17
    v_mul_f32 v64, v64, v186
    v_mul_f32 v65, v65, v186
    v_fma_f32 v170, v64, 0, v170
    v_fma_f32 v171, v65, 0, v171
    v_cvt_pk_bf16_f32 v8, v64, v65
    v_accvgpr_read_b32 v66, a18
    v_accvgpr_read_b32 v67, a19
    v_mul_f32 v66, v66, v186
    v_mul_f32 v67, v67, v186
    v_fma_f32 v170, v66, 0, v170
    v_fma_f32 v171, v67, 0, v171
    v_cvt_pk_bf16_f32 v9, v66, v67
    v_accvgpr_read_b32 v68, a20
    v_accvgpr_read_b32 v69, a21
    v_mul_f32 v68, v68, v186
    v_mul_f32 v69, v69, v186
    v_fma_f32 v170, v68, 0, v170
    v_fma_f32 v171, v69, 0, v171
    v_cvt_pk_bf16_f32 v10, v68, v69
    v_accvgpr_read_b32 v70, a22
    v_accvgpr_read_b32 v71, a23
    v_mul_f32 v70, v70, v186
    v_mul_f32 v71, v71, v186
    v_fma_f32 v170, v70, 0, v170
    v_fma_f32 v171, v71, 0, v171
    v_cvt_pk_bf16_f32 v11, v70, v71
    v_accvgpr_read_b32 v64, a24
    v_accvgpr_read_b32 v65, a25
    v_mul_f32 v64, v64, v186
    v_mul_f32 v65, v65, v186
    v_fma_f32 v170, v64, 0, v170
    v_fma_f32 v171, v65, 0, v171
    v_cvt_pk_bf16_f32 v12, v64, v65
    v_accvgpr_read_b32 v66, a26
    v_accvgpr_read_b32 v67, a27
    v_mul_f32 v66, v66, v186
    v_mul_f32 v67, v67, v186
    v_fma_f32 v170, v66, 0, v170
    v_fma_f32 v171, v67, 0, v171
    v_cvt_pk_bf16_f32 v13, v66, v67
    v_accvgpr_read_b32 v68, a28
    v_accvgpr_read_b32 v69, a29
    v_mul_f32 v68, v68, v186
    v_mul_f32 v69, v69, v186
    v_fma_f32 v170, v68, 0, v170
    v_fma_f32 v171, v69, 0, v171
    v_cvt_pk_bf16_f32 v14, v68, v69
    v_accvgpr_read_b32 v70, a30
    v_accvgpr_read_b32 v71, a31
    v_mul_f32 v70, v70, v186
    v_mul_f32 v71, v71, v186
    v_fma_f32 v170, v70, 0, v170
    v_fma_f32 v171, v71, 0, v171
    v_cvt_pk_bf16_f32 v15, v70, v71
    v_accvgpr_read_b32 v64, a32
    v_accvgpr_read_b32 v65, a33
    v_mul_f32 v64, v64, v187
    v_mul_f32 v65, v65, v187
    v_fma_f32 v170, v64, 0, v170
    v_fma_f32 v171, v65, 0, v171
    v_cvt_pk_bf16_f32 v16, v64, v65
    v_accvgpr_read_b32 v66, a34
    v_accvgpr_read_b32 v67, a35
    v_mul_f32 v66, v66, v187
    v_mul_f32 v67, v67, v187
    v_fma_f32 v170, v66, 0, v170
    v_fma_f32 v171, v67, 0, v171
    v_cvt_pk_bf16_f32 v17, v66, v67
    v_accvgpr_read_b32 v68, a36
    v_accvgpr_read_b32 v69, a37
    v_mul_f32 v68, v68, v187
    v_mul_f32 v69, v69, v187
    v_fma_f32 v170, v68, 0, v170
    v_fma_f32 v171, v69, 0, v171
    v_cvt_pk_bf16_f32 v18, v68, v69
    v_accvgpr_read_b32 v70, a38
    v_accvgpr_read_b32 v71, a39
    v_mul_f32 v70, v70, v187
    v_mul_f32 v71, v71, v187
    v_fma_f32 v170, v70, 0, v170
    v_fma_f32 v171, v71, 0, v171
    v_cvt_pk_bf16_f32 v19, v70, v71
    v_accvgpr_read_b32 v64, a40
    v_accvgpr_read_b32 v65, a41
    v_mul_f32 v64, v64, v187
    v_mul_f32 v65, v65, v187
    v_fma_f32 v170, v64, 0, v170
    v_fma_f32 v171, v65, 0, v171
    v_cvt_pk_bf16_f32 v20, v64, v65
    v_accvgpr_read_b32 v66, a42
    v_accvgpr_read_b32 v67, a43
    v_mul_f32 v66, v66, v187
    v_mul_f32 v67, v67, v187
    v_fma_f32 v170, v66, 0, v170
    v_fma_f32 v171, v67, 0, v171
    v_cvt_pk_bf16_f32 v21, v66, v67
    v_accvgpr_read_b32 v68, a44
    v_accvgpr_read_b32 v69, a45
    v_mul_f32 v68, v68, v187
    v_mul_f32 v69, v69, v187
    v_fma_f32 v170, v68, 0, v170
    v_fma_f32 v171, v69, 0, v171
    v_cvt_pk_bf16_f32 v22, v68, v69
    v_accvgpr_read_b32 v70, a46
    v_accvgpr_read_b32 v71, a47
    v_mul_f32 v70, v70, v187
    v_mul_f32 v71, v71, v187
    v_fma_f32 v170, v70, 0, v170
    v_fma_f32 v171, v71, 0, v171
    v_cvt_pk_bf16_f32 v23, v70, v71
    v_accvgpr_read_b32 v64, a48
    v_accvgpr_read_b32 v65, a49
    v_mul_f32 v64, v64, v187
    v_mul_f32 v65, v65, v187
    v_fma_f32 v170, v64, 0, v170
    v_fma_f32 v171, v65, 0, v171
    v_cvt_pk_bf16_f32 v24, v64, v65
    v_accvgpr_read_b32 v66, a50
    v_accvgpr_read_b32 v67, a51
    v_mul_f32 v66, v66, v187
    v_mul_f32 v67, v67, v187
    v_fma_f32 v170, v66, 0, v170
    v_fma_f32 v171, v67, 0, v171
    v_cvt_pk_bf16_f32 v25, v66, v67
    v_accvgpr_read_b32 v68, a52
    v_accvgpr_read_b32 v69, a53
    v_mul_f32 v68, v68, v187
    v_mul_f32 v69, v69, v187
    v_fma_f32 v170, v68, 0, v170
    v_fma_f32 v171, v69, 0, v171
    v_cvt_pk_bf16_f32 v26, v68, v69
    v_accvgpr_read_b32 v70, a54
    v_accvgpr_read_b32 v71, a55
    v_mul_f32 v70, v70, v187
    v_mul_f32 v71, v71, v187
    v_fma_f32 v170, v70, 0, v170
    v_fma_f32 v171, v71, 0, v171
    v_cvt_pk_bf16_f32 v27, v70, v71
    v_accvgpr_read_b32 v64, a56
    v_accvgpr_read_b32 v65, a57
    v_mul_f32 v64, v64, v187
    v_mul_f32 v65, v65, v187
    v_fma_f32 v170, v64, 0, v170
    v_fma_f32 v171, v65, 0, v171
    v_cvt_pk_bf16_f32 v28, v64, v65
    v_accvgpr_read_b32 v66, a58
    v_accvgpr_read_b32 v67, a59
    v_mul_f32 v66, v66, v187
    v_mul_f32 v67, v67, v187
    v_fma_f32 v170, v66, 0, v170
    v_fma_f32 v171, v67, 0, v171
    v_cvt_pk_bf16_f32 v29, v66, v67
    v_accvgpr_read_b32 v68, a60
    v_accvgpr_read_b32 v69, a61
    v_mul_f32 v68, v68, v187
    v_mul_f32 v69, v69, v187
    v_fma_f32 v170, v68, 0, v170
    v_fma_f32 v171, v69, 0, v171
    v_cvt_pk_bf16_f32 v30, v68, v69
    v_accvgpr_read_b32 v70, a62
    v_accvgpr_read_b32 v71, a63
    v_mul_f32 v70, v70, v187
    v_mul_f32 v71, v71, v187
    v_fma_f32 v170, v70, 0, v170
    v_fma_f32 v171, v71, 0, v171
    v_cvt_pk_bf16_f32 v31, v70, v71
    v_accvgpr_read_b32 v64, a64
    v_accvgpr_read_b32 v65, a65
    v_mul_f32 v64, v64, v188
    v_mul_f32 v65, v65, v188
    v_fma_f32 v170, v64, 0, v170
    v_fma_f32 v171, v65, 0, v171
    v_cvt_pk_bf16_f32 v32, v64, v65
    v_accvgpr_read_b32 v66, a66
    v_accvgpr_read_b32 v67, a67
    v_mul_f32 v66, v66, v188
    v_mul_f32 v67, v67, v188
    v_fma_f32 v170, v66, 0, v170
    v_fma_f32 v171, v67, 0, v171
    v_cvt_pk_bf16_f32 v33, v66, v67
    v_accvgpr_read_b32 v68, a68
    v_accvgpr_read_b32 v69, a69
    v_mul_f32 v68, v68, v188
    v_mul_f32 v69, v69, v188
    v_fma_f32 v170, v68, 0, v170
    v_fma_f32 v171, v69, 0, v171
    v_cvt_pk_bf16_f32 v34, v68, v69
    v_accvgpr_read_b32 v70, a70
    v_accvgpr_read_b32 v71, a71
    v_mul_f32 v70, v70, v188
    v_mul_f32 v71, v71, v188
    v_fma_f32 v170, v70, 0, v170
    v_fma_f32 v171, v71, 0, v171
    v_cvt_pk_bf16_f32 v35, v70, v71
    v_accvgpr_read_b32 v64, a72
    v_accvgpr_read_b32 v65, a73
    v_mul_f32 v64, v64, v188
    v_mul_f32 v65, v65, v188
    v_fma_f32 v170, v64, 0, v170
    v_fma_f32 v171, v65, 0, v171
    v_cvt_pk_bf16_f32 v36, v64, v65
    v_accvgpr_read_b32 v66, a74
    v_accvgpr_read_b32 v67, a75
    v_mul_f32 v66, v66, v188
    v_mul_f32 v67, v67, v188
    v_fma_f32 v170, v66, 0, v170
    v_fma_f32 v171, v67, 0, v171
    v_cvt_pk_bf16_f32 v37, v66, v67
    v_accvgpr_read_b32 v68, a76
    v_accvgpr_read_b32 v69, a77
    v_mul_f32 v68, v68, v188
    v_mul_f32 v69, v69, v188
    v_fma_f32 v170, v68, 0, v170
    v_fma_f32 v171, v69, 0, v171
    v_cvt_pk_bf16_f32 v38, v68, v69
    v_accvgpr_read_b32 v70, a78
    v_accvgpr_read_b32 v71, a79
    v_mul_f32 v70, v70, v188
    v_mul_f32 v71, v71, v188
    v_fma_f32 v170, v70, 0, v170
    v_fma_f32 v171, v71, 0, v171
    v_cvt_pk_bf16_f32 v39, v70, v71
    v_accvgpr_read_b32 v64, a80
    v_accvgpr_read_b32 v65, a81
    v_mul_f32 v64, v64, v188
    v_mul_f32 v65, v65, v188
    v_fma_f32 v170, v64, 0, v170
    v_fma_f32 v171, v65, 0, v171
    v_cvt_pk_bf16_f32 v40, v64, v65
    v_accvgpr_read_b32 v66, a82
    v_accvgpr_read_b32 v67, a83
    v_mul_f32 v66, v66, v188
    v_mul_f32 v67, v67, v188
    v_fma_f32 v170, v66, 0, v170
    v_fma_f32 v171, v67, 0, v171
    v_cvt_pk_bf16_f32 v41, v66, v67
    v_accvgpr_read_b32 v68, a84
    v_accvgpr_read_b32 v69, a85
    v_mul_f32 v68, v68, v188
    v_mul_f32 v69, v69, v188
    v_fma_f32 v170, v68, 0, v170
    v_fma_f32 v171, v69, 0, v171
    v_cvt_pk_bf16_f32 v42, v68, v69
    v_accvgpr_read_b32 v70, a86
    v_accvgpr_read_b32 v71, a87
    v_mul_f32 v70, v70, v188
    v_mul_f32 v71, v71, v188
    v_fma_f32 v170, v70, 0, v170
    v_fma_f32 v171, v71, 0, v171
    v_cvt_pk_bf16_f32 v43, v70, v71
    v_accvgpr_read_b32 v64, a88
    v_accvgpr_read_b32 v65, a89
    v_mul_f32 v64, v64, v188
    v_mul_f32 v65, v65, v188
    v_fma_f32 v170, v64, 0, v170
    v_fma_f32 v171, v65, 0, v171
    v_cvt_pk_bf16_f32 v44, v64, v65
    v_accvgpr_read_b32 v66, a90
    v_accvgpr_read_b32 v67, a91
    v_mul_f32 v66, v66, v188
    v_mul_f32 v67, v67, v188
    v_fma_f32 v170, v66, 0, v170
    v_fma_f32 v171, v67, 0, v171
    v_cvt_pk_bf16_f32 v45, v66, v67
    v_accvgpr_read_b32 v68, a92
    v_accvgpr_read_b32 v69, a93
    v_mul_f32 v68, v68, v188
    v_mul_f32 v69, v69, v188
    v_fma_f32 v170, v68, 0, v170
    v_fma_f32 v171, v69, 0, v171
    v_cvt_pk_bf16_f32 v46, v68, v69
    v_accvgpr_read_b32 v70, a94
    v_accvgpr_read_b32 v71, a95
    v_mul_f32 v70, v70, v188
    v_mul_f32 v71, v71, v188
    v_fma_f32 v170, v70, 0, v170
    v_fma_f32 v171, v71, 0, v171
    v_cvt_pk_bf16_f32 v47, v70, v71
    v_accvgpr_read_b32 v64, a96
    v_accvgpr_read_b32 v65, a97
    v_mul_f32 v64, v64, v189
    v_mul_f32 v65, v65, v189
    v_fma_f32 v170, v64, 0, v170
    v_fma_f32 v171, v65, 0, v171
    v_cvt_pk_bf16_f32 v48, v64, v65
    v_accvgpr_read_b32 v66, a98
    v_accvgpr_read_b32 v67, a99
    v_mul_f32 v66, v66, v189
    v_mul_f32 v67, v67, v189
    v_fma_f32 v170, v66, 0, v170
    v_fma_f32 v171, v67, 0, v171
    v_cvt_pk_bf16_f32 v49, v66, v67
    v_accvgpr_read_b32 v68, a100
    v_accvgpr_read_b32 v69, a101
    v_mul_f32 v68, v68, v189
    v_mul_f32 v69, v69, v189
    v_fma_f32 v170, v68, 0, v170
    v_fma_f32 v171, v69, 0, v171
    v_cvt_pk_bf16_f32 v50, v68, v69
    v_accvgpr_read_b32 v70, a102
    v_accvgpr_read_b32 v71, a103
    v_mul_f32 v70, v70, v189
    v_mul_f32 v71, v71, v189
    v_fma_f32 v170, v70, 0, v170
    v_fma_f32 v171, v71, 0, v171
    v_cvt_pk_bf16_f32 v51, v70, v71
    v_accvgpr_read_b32 v64, a104
    v_accvgpr_read_b32 v65, a105
    v_mul_f32 v64, v64, v189
    v_mul_f32 v65, v65, v189
    v_fma_f32 v170, v64, 0, v170
    v_fma_f32 v171, v65, 0, v171
    v_cvt_pk_bf16_f32 v52, v64, v65
    v_accvgpr_read_b32 v66, a106
    v_accvgpr_read_b32 v67, a107
    v_mul_f32 v66, v66, v189
    v_mul_f32 v67, v67, v189
    v_fma_f32 v170, v66, 0, v170
    v_fma_f32 v171, v67, 0, v171
    v_cvt_pk_bf16_f32 v53, v66, v67
    v_accvgpr_read_b32 v68, a108
    v_accvgpr_read_b32 v69, a109
    v_mul_f32 v68, v68, v189
    v_mul_f32 v69, v69, v189
    v_fma_f32 v170, v68, 0, v170
    v_fma_f32 v171, v69, 0, v171
    v_cvt_pk_bf16_f32 v54, v68, v69
    v_accvgpr_read_b32 v70, a110
    v_accvgpr_read_b32 v71, a111
    v_mul_f32 v70, v70, v189
    v_mul_f32 v71, v71, v189
    v_fma_f32 v170, v70, 0, v170
    v_fma_f32 v171, v71, 0, v171
    v_cvt_pk_bf16_f32 v55, v70, v71
    v_accvgpr_read_b32 v64, a112
    v_accvgpr_read_b32 v65, a113
    v_mul_f32 v64, v64, v189
    v_mul_f32 v65, v65, v189
    v_fma_f32 v170, v64, 0, v170
    v_fma_f32 v171, v65, 0, v171
    v_cvt_pk_bf16_f32 v56, v64, v65
    v_accvgpr_read_b32 v66, a114
    v_accvgpr_read_b32 v67, a115
    v_mul_f32 v66, v66, v189
    v_mul_f32 v67, v67, v189
    v_fma_f32 v170, v66, 0, v170
    v_fma_f32 v171, v67, 0, v171
    v_cvt_pk_bf16_f32 v57, v66, v67
    v_accvgpr_read_b32 v68, a116
    v_accvgpr_read_b32 v69, a117
    v_mul_f32 v68, v68, v189
    v_mul_f32 v69, v69, v189
    v_fma_f32 v170, v68, 0, v170
    v_fma_f32 v171, v69, 0, v171
    v_cvt_pk_bf16_f32 v58, v68, v69
    v_accvgpr_read_b32 v70, a118
    v_accvgpr_read_b32 v71, a119
    v_mul_f32 v70, v70, v189
    v_mul_f32 v71, v71, v189
    v_fma_f32 v170, v70, 0, v170
    v_fma_f32 v171, v71, 0, v171
    v_cvt_pk_bf16_f32 v59, v70, v71
    v_accvgpr_read_b32 v64, a120
    v_accvgpr_read_b32 v65, a121
    v_mul_f32 v64, v64, v189
    v_mul_f32 v65, v65, v189
    v_fma_f32 v170, v64, 0, v170
    v_fma_f32 v171, v65, 0, v171
    v_cvt_pk_bf16_f32 v60, v64, v65
    v_accvgpr_read_b32 v66, a122
    v_accvgpr_read_b32 v67, a123
    v_mul_f32 v66, v66, v189
    v_mul_f32 v67, v67, v189
    v_fma_f32 v170, v66, 0, v170
    v_fma_f32 v171, v67, 0, v171
    v_cvt_pk_bf16_f32 v61, v66, v67
    v_accvgpr_read_b32 v68, a124
    v_accvgpr_read_b32 v69, a125
    v_mul_f32 v68, v68, v189
    v_mul_f32 v69, v69, v189
    v_fma_f32 v170, v68, 0, v170
    v_fma_f32 v171, v69, 0, v171
    v_cvt_pk_bf16_f32 v62, v68, v69
    v_accvgpr_read_b32 v70, a126
    v_accvgpr_read_b32 v71, a127
    v_mul_f32 v70, v70, v189
    v_mul_f32 v71, v71, v189
    v_fma_f32 v170, v70, 0, v170
    v_fma_f32 v171, v71, 0, v171
    v_cvt_pk_bf16_f32 v63, v70, v71
    v_cmp_u_f32 vcc, v170, v171
    s_or_b64 s[40:41], s[40:41], s[42:43]
    s_or_b64 vcc, vcc, s[40:41]
    s_cmp_lg_u32 s24, 0
    s_cbranch_scc1 L_store
    s_cbranch_vccnz L_fallback
L_store:
    buffer_store_dwordx4 v[0:3], v180, s[12:15], s35 offen offset:0 nt
    buffer_store_dwordx4 v[4:7], v180, s[12:15], s35 offen offset:64 nt
    buffer_store_dwordx4 v[8:11], v180, s[12:15], s35 offen offset:128 nt
    buffer_store_dwordx4 v[12:15], v180, s[12:15], s35 offen offset:192 nt
    buffer_store_dwordx4 v[16:19], v180, s[12:15], s36 offen offset:0 nt
    buffer_store_dwordx4 v[20:23], v180, s[12:15], s36 offen offset:64 nt
    buffer_store_dwordx4 v[24:27], v180, s[12:15], s36 offen offset:128 nt
    buffer_store_dwordx4 v[28:31], v180, s[12:15], s36 offen offset:192 nt
    buffer_store_dwordx4 v[32:35], v180, s[12:15], s37 offen offset:0 nt
    buffer_store_dwordx4 v[36:39], v180, s[12:15], s37 offen offset:64 nt
    buffer_store_dwordx4 v[40:43], v180, s[12:15], s37 offen offset:128 nt
    buffer_store_dwordx4 v[44:47], v180, s[12:15], s37 offen offset:192 nt
    buffer_store_dwordx4 v[48:51], v180, s[12:15], s38 offen offset:0 nt
    buffer_store_dwordx4 v[52:55], v180, s[12:15], s38 offen offset:64 nt
    buffer_store_dwordx4 v[56:59], v180, s[12:15], s38 offen offset:128 nt
    buffer_store_dwordx4 v[60:63], v180, s[12:15], s38 offen offset:192 nt
L_fin:
L_done:
    s_endpgm
L_selfhelp:
    s_waitcnt vmcnt(0) lgkmcnt(0)
    s_barrier
    s_mov_b32 s92, 1
    s_mov_b32 s72, 0
L_sh_tile:
    v_mov_b32 v245, 131072
    s_lshl_b32 s75, s33, 5
    s_add_u32 s75, s75, s72
    s_lshl_b32 s76, s75, 8
    s_lshl_b32 s77, s75, 6
    s_lshl_b32 s74, s73, 4
    s_add_u32 s74, s74, s77
    s_lshl_b32 s74, s74, 9
    buffer_load_dwordx4 v[16:19], v240, s[44:47], s74 offen offset:0
    buffer_load_dwordx4 v[20:23], v240, s[44:47], s74 offen offset:16
    buffer_load_dwordx4 v[24:27], v240, s[44:47], s74 offen offset:128
    buffer_load_dwordx4 v[28:31], v240, s[44:47], s74 offen offset:144
    buffer_load_dwordx4 v[32:35], v240, s[44:47], s74 offen offset:256
    buffer_load_dwordx4 v[36:39], v240, s[44:47], s74 offen offset:272
    buffer_load_dwordx4 v[40:43], v240, s[44:47], s74 offen offset:384
    buffer_load_dwordx4 v[44:47], v240, s[44:47], s74 offen offset:400
    buffer_load_dwordx4 v[48:51], v241, s[52:55], s76 offen offset:0
    buffer_load_dwordx4 v[64:67], v241, s[56:59], s76 offen offset:0
    buffer_load_dwordx4 v[52:55], v241, s[52:55], s76 offen offset:64
    buffer_load_dwordx4 v[68:71], v241, s[56:59], s76 offen offset:64
    buffer_load_dwordx4 v[56:59], v241, s[52:55], s76 offen offset:128
    buffer_load_dwordx4 v[72:75], v241, s[56:59], s76 offen offset:128
    buffer_load_dwordx4 v[60:63], v241, s[52:55], s76 offen offset:192
    buffer_load_dwordx4 v[76:79], v241, s[56:59], s76 offen offset:192
    s_lshr_b32 s78, s73, 1
    s_and_b32 s79, s73, 1
    s_lshl_b32 s75, s78, 5
    s_add_u32 s77, s77, s75
    s_lshl_b32 s75, s79, 3
    s_add_u32 s77, s77, s75
    s_lshl_b32 s80, s77, 1
    s_lshl_b32 s77, s77, 9
    s_add_u32 s81, s77, 8192
    buffer_load_dwordx4 v[128:131], v242, s[48:51], s77 offen offset:0
    buffer_load_dwordx4 v[132:135], v242, s[48:51], s77 offen offset:512
    buffer_load_dwordx4 v[136:139], v242, s[48:51], s77 offen offset:1024
    buffer_load_dwordx4 v[140:143], v242, s[48:51], s77 offen offset:1536
    buffer_load_dwordx4 v[144:147], v242, s[48:51], s81 offen offset:0
    buffer_load_dwordx4 v[148:151], v242, s[48:51], s81 offen offset:512
    buffer_load_dwordx4 v[152:155], v242, s[48:51], s81 offen offset:1024
    buffer_load_dwordx4 v[156:159], v242, s[48:51], s81 offen offset:1536
    buffer_load_dwordx2 v[192:193], v243, s[60:63], s80 offen
    buffer_load_dwordx2 v[194:195], v243, s[60:63], s80 offen offset:32
    buffer_load_dwordx2 v[196:197], v243, s[64:67], s80 offen
    buffer_load_dwordx2 v[198:199], v243, s[64:67], s80 offen offset:32
    s_lshl_b32 s82, s72, 15
    s_add_u32 s83, s82, 0x8000
    s_and_b32 s83, s83, 0xfffff
    s_add_u32 s83, s83, 8192
    s_lshl_b32 s75, s78, 10
    s_add_u32 s83, s83, s75
    s_lshl_b32 s75, s79, 9
    s_add_u32 s83, s83, s75
    s_add_u32 s83, s83, s22
    s_lshl_b32 s75, s73, 12
    s_add_u32 s82, s82, s75
    s_sub_u32 s82, s82, 8192
    s_and_b32 s82, s82, 0xfffff
    s_add_u32 s82, s82, s22
    s_waitcnt vmcnt(12)
    s_mov_b32 s88, 0
    s_mov_b32 s89, 0
L_dk1:
    s_set_gpr_idx_on s88, gpr_idx(SRC0)
    s_nop 1
    v_cvt_f32_i32 v80, v16
    v_cvt_f32_i32 v81, v17
    v_cvt_f32_i32 v82, v18
    v_cvt_f32_i32 v83, v19
    v_cvt_f32_i32 v84, v20
    v_cvt_f32_i32 v85, v21
    v_cvt_f32_i32 v86, v22
    v_cvt_f32_i32 v87, v23
    s_set_gpr_idx_idx s89
    s_set_gpr_idx_mode gpr_idx(SRC1)
    s_nop 1
    v_lshlrev_b32 v88, 16, v64
    v_and_b32 v89, s84, v64
    v_lshlrev_b32 v96, 16, v48
    v_and_b32 v97, s84, v48
    v_lshlrev_b32 v90, 16, v65
    v_and_b32 v91, s84, v65
    v_lshlrev_b32 v98, 16, v49
    v_and_b32 v99, s84, v49
    v_lshlrev_b32 v92, 16, v66
    v_and_b32 v93, s84, v66
    v_lshlrev_b32 v100, 16, v50
    v_and_b32 v101, s84, v50
    v_lshlrev_b32 v94, 16, v67
    v_and_b32 v95, s84, v67
    v_lshlrev_b32 v102, 16, v51
    v_and_b32 v103, s84, v51
    s_set_gpr_idx_off
    s_nop 1
    v_pk_add_f32 v[80:81], v[80:81], v[88:89] neg_lo:[0,1] neg_hi:[0,1]
    v_pk_add_f32 v[82:83], v[82:83], v[90:91] neg_lo:[0,1] neg_hi:[0,1]
    v_pk_add_f32 v[84:85], v[84:85], v[92:93] neg_lo:[0,1] neg_hi:[0,1]
    v_pk_add_f32 v[86:87], v[86:87], v[94:95] neg_lo:[0,1] neg_hi:[0,1]
    v_cvt_pk_bf16_f32 v104, v80, v81
    v_cvt_pk_bf16_f32 v105, v82, v83
    v_cvt_pk_bf16_f32 v106, v84, v85
    v_cvt_pk_bf16_f32 v107, v86, v87
    v_lshlrev_b32 v80, 16, v104
    v_and_b32 v81, s84, v104
    v_lshlrev_b32 v82, 16, v105
    v_and_b32 v83, s84, v105
    v_lshlrev_b32 v84, 16, v106
    v_and_b32 v85, s84, v106
    v_lshlrev_b32 v86, 16, v107
    v_and_b32 v87, s84, v107
    v_pk_mul_f32 v[80:81], v[80:81], v[96:97]
    v_pk_mul_f32 v[82:83], v[82:83], v[98:99]
    v_pk_mul_f32 v[84:85], v[84:85], v[100:101]
    v_pk_mul_f32 v[86:87], v[86:87], v[102:103]
    v_cvt_pk_bf16_f32 v104, v80, v81
    v_cvt_pk_bf16_f32 v105, v82, v83
    v_cvt_pk_bf16_f32 v106, v84, v85
    v_cvt_pk_bf16_f32 v107, v86, v87
    v_lshlrev_b32 v80, 16, v104
    v_and_b32 v81, s84, v104
    v_lshlrev_b32 v82, 16, v105
    v_and_b32 v83, s84, v105
    v_lshlrev_b32 v84, 16, v106
    v_and_b32 v85, s84, v106
    v_lshlrev_b32 v86, 16, v107
    v_and_b32 v87, s84, v107
    v_pk_mul_f32 v[80:81], v[80:81], s[86:87]
    v_pk_mul_f32 v[82:83], v[82:83], s[86:87]
    v_pk_mul_f32 v[84:85], v[84:85], s[86:87]
    v_pk_mul_f32 v[86:87], v[86:87], s[86:87]
    v_cvt_pk_bf16_f32 v108, v80, v81
    v_cvt_pk_bf16_f32 v109, v82, v83
    v_cvt_pk_bf16_f32 v110, v84, v85
    v_cvt_pk_bf16_f32 v111, v86, v87
    buffer_store_dwordx4 v[108:111], v164, s[4:7], s82 offen sc1
    ds_write_b128 v245, v[108:111]
    v_add_u32 v245, 0x400, v245
    s_add_u32 s82, s82, 0x400
    s_add_u32 s88, s88, 8
    s_add_u32 s89, s89, 4
    s_cmp_lt_u32 s89, 16
    s_cbranch_scc1 L_dk1
    s_waitcnt vmcnt(4)
    v_lshlrev_b32 v96, 16, v192
    v_and_b32 v97, s84, v192
    v_lshlrev_b32 v88, 16, v196
    v_and_b32 v89, s84, v196
    v_lshlrev_b32 v98, 16, v193
    v_and_b32 v99, s84, v193
    v_lshlrev_b32 v90, 16, v197
    v_and_b32 v91, s84, v197
    v_lshlrev_b32 v100, 16, v194
    v_and_b32 v101, s84, v194
    v_lshlrev_b32 v92, 16, v198
    v_and_b32 v93, s84, v198
    v_lshlrev_b32 v102, 16, v195
    v_and_b32 v103, s84, v195
    v_lshlrev_b32 v94, 16, v199
    v_and_b32 v95, s84, v199
    s_mov_b32 s89, 0
L_dv1:
    s_set_gpr_idx_on s89, gpr_idx(SRC0)
    s_nop 1
    v_cvt_f32_i32 v80, v128
    v_cvt_f32_i32 v81, v132
    v_cvt_f32_i32 v82, v136
    v_cvt_f32_i32 v83, v140
    v_cvt_f32_i32 v84, v144
    v_cvt_f32_i32 v85, v148
    v_cvt_f32_i32 v86, v152
    v_cvt_f32_i32 v87, v156
    s_set_gpr_idx_off
    s_nop 1
    v_pk_add_f32 v[80:81], v[80:81], v[88:89] neg_lo:[0,1] neg_hi:[0,1]
    v_pk_add_f32 v[82:83], v[82:83], v[90:91] neg_lo:[0,1] neg_hi:[0,1]
    v_pk_add_f32 v[84:85], v[84:85], v[92:93] neg_lo:[0,1] neg_hi:[0,1]
    v_pk_add_f32 v[86:87], v[86:87], v[94:95] neg_lo:[0,1] neg_hi:[0,1]
    v_cvt_pk_bf16_f32 v104, v80, v81
    v_cvt_pk_bf16_f32 v105, v82, v83
    v_cvt_pk_bf16_f32 v106, v84, v85
    v_cvt_pk_bf16_f32 v107, v86, v87
    v_lshlrev_b32 v80, 16, v104
    v_and_b32 v81, s84, v104
    v_lshlrev_b32 v82, 16, v105
    v_and_b32 v83, s84, v105
    v_lshlrev_b32 v84, 16, v106
    v_and_b32 v85, s84, v106
    v_lshlrev_b32 v86, 16, v107
    v_and_b32 v87, s84, v107
    v_pk_mul_f32 v[80:81], v[80:81], v[96:97]
    v_pk_mul_f32 v[82:83], v[82:83], v[98:99]
    v_pk_mul_f32 v[84:85], v[84:85], v[100:101]
    v_pk_mul_f32 v[86:87], v[86:87], v[102:103]
    v_cvt_pk_bf16_f32 v108, v80, v81
    v_cvt_pk_bf16_f32 v109, v82, v83
    v_cvt_pk_bf16_f32 v110, v84, v85
    v_cvt_pk_bf16_f32 v111, v86, v87
    ds_write_b128 v244, v[108:111]
    v_add_u32 v244, 16, v244
    s_add_u32 s89, s89, 1
    s_cmp_lt_u32 s89, 4
    s_cbranch_scc1 L_dv1
    v_add_u32 v244, -64, v244
    ds_read_b128 v[16:19], v191 offset:0
    ds_read_b128 v[20:23], v191 offset:4096
    ds_read_b128 v[24:27], v191 offset:8192
    ds_read_b128 v[28:31], v191 offset:12288
    s_waitcnt lgkmcnt(3)
    buffer_store_dwordx4 v[16:19], v247, s[4:7], s83 offen sc1
    s_add_u32 s83, s83, 0x1000
    s_waitcnt lgkmcnt(2)
    buffer_store_dwordx4 v[20:23], v247, s[4:7], s83 offen sc1
    s_add_u32 s83, s83, 0x1000
    s_waitcnt lgkmcnt(1)
    buffer_store_dwordx4 v[24:27], v247, s[4:7], s83 offen sc1
    s_add_u32 s83, s83, 0x1000
    s_waitcnt lgkmcnt(0)
    buffer_store_dwordx4 v[28:31], v247, s[4:7], s83 offen sc1
    s_waitcnt vmcnt(0) lgkmcnt(0)
    s_add_u32 s72, s72, 1
    s_cmp_lt_u32 s72, 32
    s_cbranch_scc1 L_sh_tile
    s_barrier
    buffer_inv sc1
    s_waitcnt vmcnt(0)
    s_barrier
    s_branch L_go
L_fallback:
    s_waitcnt vmcnt(0)
    s_mov_b32 s24, 1
    v_accvgpr_write_b32 a0, 0
    v_accvgpr_write_b32 a1, 0
    v_accvgpr_write_b32 a2, 0
    v_accvgpr_write_b32 a3, 0
    v_accvgpr_write_b32 a4, 0
    v_accvgpr_write_b32 a5, 0
    v_accvgpr_write_b32 a6, 0
    v_accvgpr_write_b32 a7, 0
    v_accvgpr_write_b32 a8, 0
    v_accvgpr_write_b32 a9, 0
    v_accvgpr_write_b32 a10, 0
    v_accvgpr_write_b32 a11, 0
    v_accvgpr_write_b32 a12, 0
    v_accvgpr_write_b32 a13, 0
    v_accvgpr_write_b32 a14, 0
    v_accvgpr_write_b32 a15, 0
    v_accvgpr_write_b32 a16, 0
    v_accvgpr_write_b32 a17, 0
    v_accvgpr_write_b32 a18, 0
    v_accvgpr_write_b32 a19, 0
    v_accvgpr_write_b32 a20, 0
    v_accvgpr_write_b32 a21, 0
    v_accvgpr_write_b32 a22, 0
    v_accvgpr_write_b32 a23, 0
    v_accvgpr_write_b32 a24, 0
    v_accvgpr_write_b32 a25, 0
    v_accvgpr_write_b32 a26, 0
    v_accvgpr_write_b32 a27, 0
    v_accvgpr_write_b32 a28, 0
    v_accvgpr_write_b32 a29, 0
    v_accvgpr_write_b32 a30, 0
    v_accvgpr_write_b32 a31, 0
    v_accvgpr_write_b32 a32, 0
    v_accvgpr_write_b32 a33, 0
    v_accvgpr_write_b32 a34, 0
    v_accvgpr_write_b32 a35, 0
    v_accvgpr_write_b32 a36, 0
    v_accvgpr_write_b32 a37, 0
    v_accvgpr_write_b32 a38, 0
    v_accvgpr_write_b32 a39, 0
    v_accvgpr_write_b32 a40, 0
    v_accvgpr_write_b32 a41, 0
    v_accvgpr_write_b32 a42, 0
    v_accvgpr_write_b32 a43, 0
    v_accvgpr_write_b32 a44, 0
    v_accvgpr_write_b32 a45, 0
    v_accvgpr_write_b32 a46, 0
    v_accvgpr_write_b32 a47, 0
    v_accvgpr_write_b32 a48, 0
    v_accvgpr_write_b32 a49, 0
    v_accvgpr_write_b32 a50, 0
    v_accvgpr_write_b32 a51, 0
    v_accvgpr_write_b32 a52, 0
    v_accvgpr_write_b32 a53, 0
    v_accvgpr_write_b32 a54, 0
    v_accvgpr_write_b32 a55, 0
    v_accvgpr_write_b32 a56, 0
    v_accvgpr_write_b32 a57, 0
    v_accvgpr_write_b32 a58, 0
    v_accvgpr_write_b32 a59, 0
    v_accvgpr_write_b32 a60, 0
    v_accvgpr_write_b32 a61, 0
    v_accvgpr_write_b32 a62, 0
    v_accvgpr_write_b32 a63, 0
    v_accvgpr_write_b32 a64, 0
    v_accvgpr_write_b32 a65, 0
    v_accvgpr_write_b32 a66, 0
    v_accvgpr_write_b32 a67, 0
    v_accvgpr_write_b32 a68, 0
    v_accvgpr_write_b32 a69, 0
    v_accvgpr_write_b32 a70, 0
    v_accvgpr_write_b32 a71, 0
    v_accvgpr_write_b32 a72, 0
    v_accvgpr_write_b32 a73, 0
    v_accvgpr_write_b32 a74, 0
    v_accvgpr_write_b32 a75, 0
    v_accvgpr_write_b32 a76, 0
    v_accvgpr_write_b32 a77, 0
    v_accvgpr_write_b32 a78, 0
    v_accvgpr_write_b32 a79, 0
    v_accvgpr_write_b32 a80, 0
    v_accvgpr_write_b32 a81, 0
    v_accvgpr_write_b32 a82, 0
    v_accvgpr_write_b32 a83, 0
    v_accvgpr_write_b32 a84, 0
    v_accvgpr_write_b32 a85, 0
    v_accvgpr_write_b32 a86, 0
    v_accvgpr_write_b32 a87, 0
    v_accvgpr_write_b32 a88, 0
    v_accvgpr_write_b32 a89, 0
    v_accvgpr_write_b32 a90, 0
    v_accvgpr_write_b32 a91, 0
    v_accvgpr_write_b32 a92, 0
    v_accvgpr_write_b32 a93, 0
    v_accvgpr_write_b32 a94, 0
    v_accvgpr_write_b32 a95, 0
    v_accvgpr_write_b32 a96, 0
    v_accvgpr_write_b32 a97, 0
    v_accvgpr_write_b32 a98, 0
    v_accvgpr_write_b32 a99, 0
    v_accvgpr_write_b32 a100, 0
    v_accvgpr_write_b32 a101, 0
    v_accvgpr_write_b32 a102, 0
    v_accvgpr_write_b32 a103, 0
    v_accvgpr_write_b32 a104, 0
    v_accvgpr_write_b32 a105, 0
    v_accvgpr_write_b32 a106, 0
    v_accvgpr_write_b32 a107, 0
    v_accvgpr_write_b32 a108, 0
    v_accvgpr_write_b32 a109, 0
    v_accvgpr_write_b32 a110, 0
    v_accvgpr_write_b32 a111, 0
    v_accvgpr_write_b32 a112, 0
    v_accvgpr_write_b32 a113, 0
    v_accvgpr_write_b32 a114, 0
    v_accvgpr_write_b32 a115, 0
    v_accvgpr_write_b32 a116, 0
    v_accvgpr_write_b32 a117, 0
    v_accvgpr_write_b32 a118, 0
    v_accvgpr_write_b32 a119, 0
    v_accvgpr_write_b32 a120, 0
    v_accvgpr_write_b32 a121, 0
    v_accvgpr_write_b32 a122, 0
    v_accvgpr_write_b32 a123, 0
    v_accvgpr_write_b32 a124, 0
    v_accvgpr_write_b32 a125, 0
    v_accvgpr_write_b32 a126, 0
    v_accvgpr_write_b32 a127, 0
    v_accvgpr_write_b32 a224, 0
    v_accvgpr_write_b32 a225, 0
    v_accvgpr_write_b32 a226, 0
    v_accvgpr_write_b32 a227, 0
    v_accvgpr_write_b32 a228, 0
    v_accvgpr_write_b32 a229, 0
    v_accvgpr_write_b32 a230, 0
    v_accvgpr_write_b32 a231, 0
    v_accvgpr_write_b32 a232, 0
    v_accvgpr_write_b32 a233, 0
    v_accvgpr_write_b32 a234, 0
    v_accvgpr_write_b32 a235, 0
    v_accvgpr_write_b32 a236, 0
    v_accvgpr_write_b32 a237, 0
    v_accvgpr_write_b32 a238, 0
    v_accvgpr_write_b32 a239, 0
    v_mov_b32 v182, 0xff61b1e6
    v_mov_b32 v183, 0xff61b1e6
    v_mov_b32 v184, 0xff61b1e6
    v_mov_b32 v185, 0xff61b1e6
    s_mov_b32 s39, 0
    s_mov_b32 s16, 32
L_fb_loop:
    s_add_u32 s17, s39, 0xffffe000
    s_and_b32 s17, s17, 0xfffff
    s_add_u32 s17, s17, s22
    buffer_load_dwordx4 a[192:195], v164, s[4:7], s17 offen offset:0 sc1
    buffer_load_dwordx4 a[196:199], v164, s[4:7], s17 offen offset:1024 sc1
    buffer_load_dwordx4 a[200:203], v164, s[4:7], s17 offen offset:2048 sc1
    buffer_load_dwordx4 a[204:207], v164, s[4:7], s17 offen offset:3072 sc1
    s_add_u32 s17, s17, 0x1000
    buffer_load_dwordx4 a[208:211], v164, s[4:7], s17 offen offset:0 sc1
    buffer_load_dwordx4 a[212:215], v164, s[4:7], s17 offen offset:1024 sc1
    buffer_load_dwordx4 a[216:219], v164, s[4:7], s17 offen offset:2048 sc1
    buffer_load_dwordx4 a[220:223], v164, s[4:7], s17 offen offset:3072 sc1
    s_add_u32 s17, s17, 0x1000
    s_waitcnt vmcnt(0)
    v_mfma_f32_16x16x32_bf16 v[0:3], a[192:195], a[128:131], 0
    v_mfma_f32_16x16x32_bf16 v[0:3], a[196:199], a[132:135], v[0:3]
    v_mfma_f32_16x16x32_bf16 v[0:3], a[200:203], a[136:139], v[0:3]
    v_mfma_f32_16x16x32_bf16 v[0:3], a[204:207], a[140:143], v[0:3]
    v_mfma_f32_16x16x32_bf16 v[4:7], a[192:195], a[144:147], 0
    v_mfma_f32_16x16x32_bf16 v[4:7], a[196:199], a[148:151], v[4:7]
    v_mfma_f32_16x16x32_bf16 v[4:7], a[200:203], a[152:155], v[4:7]
    v_mfma_f32_16x16x32_bf16 v[4:7], a[204:207], a[156:159], v[4:7]
    v_mfma_f32_16x16x32_bf16 v[8:11], a[192:195], a[160:163], 0
    v_mfma_f32_16x16x32_bf16 v[8:11], a[196:199], a[164:167], v[8:11]
    v_mfma_f32_16x16x32_bf16 v[8:11], a[200:203], a[168:171], v[8:11]
    v_mfma_f32_16x16x32_bf16 v[8:11], a[204:207], a[172:175], v[8:11]
    v_mfma_f32_16x16x32_bf16 v[12:15], a[192:195], a[176:179], 0
    v_mfma_f32_16x16x32_bf16 v[12:15], a[196:199], a[180:183], v[12:15]
    v_mfma_f32_16x16x32_bf16 v[12:15], a[200:203], a[184:187], v[12:15]
    v_mfma_f32_16x16x32_bf16 v[12:15], a[204:207], a[188:191], v[12:15]
    v_mfma_f32_16x16x32_bf16 v[16:19], a[208:211], a[128:131], 0
    v_mfma_f32_16x16x32_bf16 v[16:19], a[212:215], a[132:135], v[16:19]
    v_mfma_f32_16x16x32_bf16 v[16:19], a[216:219], a[136:139], v[16:19]
    v_mfma_f32_16x16x32_bf16 v[16:19], a[220:223], a[140:143], v[16:19]
    v_mfma_f32_16x16x32_bf16 v[20:23], a[208:211], a[144:147], 0
    v_mfma_f32_16x16x32_bf16 v[20:23], a[212:215], a[148:151], v[20:23]
    v_mfma_f32_16x16x32_bf16 v[20:23], a[216:219], a[152:155], v[20:23]
    v_mfma_f32_16x16x32_bf16 v[20:23], a[220:223], a[156:159], v[20:23]
    v_mfma_f32_16x16x32_bf16 v[24:27], a[208:211], a[160:163], 0
    v_mfma_f32_16x16x32_bf16 v[24:27], a[212:215], a[164:167], v[24:27]
    v_mfma_f32_16x16x32_bf16 v[24:27], a[216:219], a[168:171], v[24:27]
    v_mfma_f32_16x16x32_bf16 v[24:27], a[220:223], a[172:175], v[24:27]
    v_mfma_f32_16x16x32_bf16 v[28:31], a[208:211], a[176:179], 0
    v_mfma_f32_16x16x32_bf16 v[28:31], a[212:215], a[180:183], v[28:31]
    v_mfma_f32_16x16x32_bf16 v[28:31], a[216:219], a[184:187], v[28:31]
    v_mfma_f32_16x16x32_bf16 v[28:31], a[220:223], a[188:191], v[28:31]
    s_nop 15
    s_add_u32 s17, s39, 0x0
    s_and_b32 s17, s17, 0xfffff
    s_add_u32 s17, s17, s22
    buffer_load_dwordx4 a[192:195], v164, s[4:7], s17 offen offset:0 sc1
    buffer_load_dwordx4 a[196:199], v164, s[4:7], s17 offen offset:1024 sc1
    buffer_load_dwordx4 a[200:203], v164, s[4:7], s17 offen offset:2048 sc1
    buffer_load_dwordx4 a[204:207], v164, s[4:7], s17 offen offset:3072 sc1
    s_add_u32 s17, s17, 0x1000
    buffer_load_dwordx4 a[208:211], v164, s[4:7], s17 offen offset:0 sc1
    buffer_load_dwordx4 a[212:215], v164, s[4:7], s17 offen offset:1024 sc1
    buffer_load_dwordx4 a[216:219], v164, s[4:7], s17 offen offset:2048 sc1
    buffer_load_dwordx4 a[220:223], v164, s[4:7], s17 offen offset:3072 sc1
    s_add_u32 s17, s17, 0x1000
    s_waitcnt vmcnt(0)
    v_mfma_f32_16x16x32_bf16 v[32:35], a[192:195], a[128:131], 0
    v_mfma_f32_16x16x32_bf16 v[32:35], a[196:199], a[132:135], v[32:35]
    v_mfma_f32_16x16x32_bf16 v[32:35], a[200:203], a[136:139], v[32:35]
    v_mfma_f32_16x16x32_bf16 v[32:35], a[204:207], a[140:143], v[32:35]
    v_mfma_f32_16x16x32_bf16 v[36:39], a[192:195], a[144:147], 0
    v_mfma_f32_16x16x32_bf16 v[36:39], a[196:199], a[148:151], v[36:39]
    v_mfma_f32_16x16x32_bf16 v[36:39], a[200:203], a[152:155], v[36:39]
    v_mfma_f32_16x16x32_bf16 v[36:39], a[204:207], a[156:159], v[36:39]
    v_mfma_f32_16x16x32_bf16 v[40:43], a[192:195], a[160:163], 0
    v_mfma_f32_16x16x32_bf16 v[40:43], a[196:199], a[164:167], v[40:43]
    v_mfma_f32_16x16x32_bf16 v[40:43], a[200:203], a[168:171], v[40:43]
    v_mfma_f32_16x16x32_bf16 v[40:43], a[204:207], a[172:175], v[40:43]
    v_mfma_f32_16x16x32_bf16 v[44:47], a[192:195], a[176:179], 0
    v_mfma_f32_16x16x32_bf16 v[44:47], a[196:199], a[180:183], v[44:47]
    v_mfma_f32_16x16x32_bf16 v[44:47], a[200:203], a[184:187], v[44:47]
    v_mfma_f32_16x16x32_bf16 v[44:47], a[204:207], a[188:191], v[44:47]
    v_mfma_f32_16x16x32_bf16 v[48:51], a[208:211], a[128:131], 0
    v_mfma_f32_16x16x32_bf16 v[48:51], a[212:215], a[132:135], v[48:51]
    v_mfma_f32_16x16x32_bf16 v[48:51], a[216:219], a[136:139], v[48:51]
    v_mfma_f32_16x16x32_bf16 v[48:51], a[220:223], a[140:143], v[48:51]
    v_mfma_f32_16x16x32_bf16 v[52:55], a[208:211], a[144:147], 0
    v_mfma_f32_16x16x32_bf16 v[52:55], a[212:215], a[148:151], v[52:55]
    v_mfma_f32_16x16x32_bf16 v[52:55], a[216:219], a[152:155], v[52:55]
    v_mfma_f32_16x16x32_bf16 v[52:55], a[220:223], a[156:159], v[52:55]
    v_mfma_f32_16x16x32_bf16 v[56:59], a[208:211], a[160:163], 0
    v_mfma_f32_16x16x32_bf16 v[56:59], a[212:215], a[164:167], v[56:59]
    v_mfma_f32_16x16x32_bf16 v[56:59], a[216:219], a[168:171], v[56:59]
    v_mfma_f32_16x16x32_bf16 v[56:59], a[220:223], a[172:175], v[56:59]
    v_mfma_f32_16x16x32_bf16 v[60:63], a[208:211], a[176:179], 0
    v_mfma_f32_16x16x32_bf16 v[60:63], a[212:215], a[180:183], v[60:63]
    v_mfma_f32_16x16x32_bf16 v[60:63], a[216:219], a[184:187], v[60:63]
    v_mfma_f32_16x16x32_bf16 v[60:63], a[220:223], a[188:191], v[60:63]
    s_nop 15
    v_max3_f32 v170, v0, v1, v182
    v_max3_f32 v170, v170, v2, v3
    v_max3_f32 v170, v170, v16, v17
    v_max3_f32 v170, v170, v18, v19
    v_max3_f32 v170, v170, v32, v33
    v_max3_f32 v170, v170, v34, v35
    v_max3_f32 v170, v170, v48, v49
    v_max3_f32 v170, v170, v50, v51
    v_max3_f32 v172, v4, v5, v183
    v_max3_f32 v172, v172, v6, v7
    v_max3_f32 v172, v172, v20, v21
    v_max3_f32 v172, v172, v22, v23
    v_max3_f32 v172, v172, v36, v37
    v_max3_f32 v172, v172, v38, v39
    v_max3_f32 v172, v172, v52, v53
    v_max3_f32 v172, v172, v54, v55
    v_max3_f32 v174, v8, v9, v184
    v_max3_f32 v174, v174, v10, v11
    v_max3_f32 v174, v174, v24, v25
    v_max3_f32 v174, v174, v26, v27
    v_max3_f32 v174, v174, v40, v41
    v_max3_f32 v174, v174, v42, v43
    v_max3_f32 v174, v174, v56, v57
    v_max3_f32 v174, v174, v58, v59
    v_max3_f32 v176, v12, v13, v185
    v_max3_f32 v176, v176, v14, v15
    v_max3_f32 v176, v176, v28, v29
    v_max3_f32 v176, v176, v30, v31
    v_max3_f32 v176, v176, v44, v45
    v_max3_f32 v176, v176, v46, v47
    v_max3_f32 v176, v176, v60, v61
    v_max3_f32 v176, v176, v62, v63
    v_mov_b32 v171, v170
    v_mov_b32 v173, v172
    v_mov_b32 v175, v174
    v_mov_b32 v177, v176
    s_nop 1
    v_permlane16_swap_b32 v170, v171
    v_permlane16_swap_b32 v172, v173
    v_permlane16_swap_b32 v174, v175
    v_permlane16_swap_b32 v176, v177
    s_nop 1
    v_max_f32 v170, v170, v171
    v_max_f32 v172, v172, v173
    v_max_f32 v174, v174, v175
    v_max_f32 v176, v176, v177
    v_mov_b32 v171, v170
    v_mov_b32 v173, v172
    v_mov_b32 v175, v174
    v_mov_b32 v177, v176
    s_nop 1
    v_permlane32_swap_b32 v170, v171
    v_permlane32_swap_b32 v172, v173
    v_permlane32_swap_b32 v174, v175
    v_permlane32_swap_b32 v176, v177
    s_nop 1
    v_max_f32 v170, v170, v171
    v_max_f32 v172, v172, v173
    v_max_f32 v174, v174, v175
    v_max_f32 v176, v176, v177
    v_sub_f32 v171, v182, v170
    v_exp_f32 v171, v171
    v_mov_b32 v182, v170
    v_accvgpr_read_b32 v178, a0
    v_mul_f32 v178, v178, v171
    v_accvgpr_write_b32 a0, v178
    v_accvgpr_read_b32 v178, a1
    v_mul_f32 v178, v178, v171
    v_accvgpr_write_b32 a1, v178
    v_accvgpr_read_b32 v178, a2
    v_mul_f32 v178, v178, v171
    v_accvgpr_write_b32 a2, v178
    v_accvgpr_read_b32 v178, a3
    v_mul_f32 v178, v178, v171
    v_accvgpr_write_b32 a3, v178
    v_accvgpr_read_b32 v178, a4
    v_mul_f32 v178, v178, v171
    v_accvgpr_write_b32 a4, v178
    v_accvgpr_read_b32 v178, a5
    v_mul_f32 v178, v178, v171
    v_accvgpr_write_b32 a5, v178
    v_accvgpr_read_b32 v178, a6
    v_mul_f32 v178, v178, v171
    v_accvgpr_write_b32 a6, v178
    v_accvgpr_read_b32 v178, a7
    v_mul_f32 v178, v178, v171
    v_accvgpr_write_b32 a7, v178
    v_accvgpr_read_b32 v178, a8
    v_mul_f32 v178, v178, v171
    v_accvgpr_write_b32 a8, v178
    v_accvgpr_read_b32 v178, a9
    v_mul_f32 v178, v178, v171
    v_accvgpr_write_b32 a9, v178
    v_accvgpr_read_b32 v178, a10
    v_mul_f32 v178, v178, v171
    v_accvgpr_write_b32 a10, v178
    v_accvgpr_read_b32 v178, a11
    v_mul_f32 v178, v178, v171
    v_accvgpr_write_b32 a11, v178
    v_accvgpr_read_b32 v178, a12
    v_mul_f32 v178, v178, v171
    v_accvgpr_write_b32 a12, v178
    v_accvgpr_read_b32 v178, a13
    v_mul_f32 v178, v178, v171
    v_accvgpr_write_b32 a13, v178
    v_accvgpr_read_b32 v178, a14
    v_mul_f32 v178, v178, v171
    v_accvgpr_write_b32 a14, v178
    v_accvgpr_read_b32 v178, a15
    v_mul_f32 v178, v178, v171
    v_accvgpr_write_b32 a15, v178
    v_accvgpr_read_b32 v178, a16
    v_mul_f32 v178, v178, v171
    v_accvgpr_write_b32 a16, v178
    v_accvgpr_read_b32 v178, a17
    v_mul_f32 v178, v178, v171
    v_accvgpr_write_b32 a17, v178
    v_accvgpr_read_b32 v178, a18
    v_mul_f32 v178, v178, v171
    v_accvgpr_write_b32 a18, v178
    v_accvgpr_read_b32 v178, a19
    v_mul_f32 v178, v178, v171
    v_accvgpr_write_b32 a19, v178
    v_accvgpr_read_b32 v178, a20
    v_mul_f32 v178, v178, v171
    v_accvgpr_write_b32 a20, v178
    v_accvgpr_read_b32 v178, a21
    v_mul_f32 v178, v178, v171
    v_accvgpr_write_b32 a21, v178
    v_accvgpr_read_b32 v178, a22
    v_mul_f32 v178, v178, v171
    v_accvgpr_write_b32 a22, v178
    v_accvgpr_read_b32 v178, a23
    v_mul_f32 v178, v178, v171
    v_accvgpr_write_b32 a23, v178
    v_accvgpr_read_b32 v178, a24
    v_mul_f32 v178, v178, v171
    v_accvgpr_write_b32 a24, v178
    v_accvgpr_read_b32 v178, a25
    v_mul_f32 v178, v178, v171
    v_accvgpr_write_b32 a25, v178
    v_accvgpr_read_b32 v178, a26
    v_mul_f32 v178, v178, v171
    v_accvgpr_write_b32 a26, v178
    v_accvgpr_read_b32 v178, a27
    v_mul_f32 v178, v178, v171
    v_accvgpr_write_b32 a27, v178
    v_accvgpr_read_b32 v178, a28
    v_mul_f32 v178, v178, v171
    v_accvgpr_write_b32 a28, v178
    v_accvgpr_read_b32 v178, a29
    v_mul_f32 v178, v178, v171
    v_accvgpr_write_b32 a29, v178
    v_accvgpr_read_b32 v178, a30
    v_mul_f32 v178, v178, v171
    v_accvgpr_write_b32 a30, v178
    v_accvgpr_read_b32 v178, a31
    v_mul_f32 v178, v178, v171
    v_accvgpr_write_b32 a31, v178
    v_accvgpr_read_b32 v178, a224
    v_mul_f32 v178, v178, v171
    v_accvgpr_write_b32 a224, v178
    v_accvgpr_read_b32 v178, a225
    v_mul_f32 v178, v178, v171
    v_accvgpr_write_b32 a225, v178
    v_accvgpr_read_b32 v178, a226
    v_mul_f32 v178, v178, v171
    v_accvgpr_write_b32 a226, v178
    v_accvgpr_read_b32 v178, a227
    v_mul_f32 v178, v178, v171
    v_accvgpr_write_b32 a227, v178
    v_sub_f32 v173, v183, v172
    v_exp_f32 v173, v173
    v_mov_b32 v183, v172
    v_accvgpr_read_b32 v178, a32
    v_mul_f32 v178, v178, v173
    v_accvgpr_write_b32 a32, v178
    v_accvgpr_read_b32 v178, a33
    v_mul_f32 v178, v178, v173
    v_accvgpr_write_b32 a33, v178
    v_accvgpr_read_b32 v178, a34
    v_mul_f32 v178, v178, v173
    v_accvgpr_write_b32 a34, v178
    v_accvgpr_read_b32 v178, a35
    v_mul_f32 v178, v178, v173
    v_accvgpr_write_b32 a35, v178
    v_accvgpr_read_b32 v178, a36
    v_mul_f32 v178, v178, v173
    v_accvgpr_write_b32 a36, v178
    v_accvgpr_read_b32 v178, a37
    v_mul_f32 v178, v178, v173
    v_accvgpr_write_b32 a37, v178
    v_accvgpr_read_b32 v178, a38
    v_mul_f32 v178, v178, v173
    v_accvgpr_write_b32 a38, v178
    v_accvgpr_read_b32 v178, a39
    v_mul_f32 v178, v178, v173
    v_accvgpr_write_b32 a39, v178
    v_accvgpr_read_b32 v178, a40
    v_mul_f32 v178, v178, v173
    v_accvgpr_write_b32 a40, v178
    v_accvgpr_read_b32 v178, a41
    v_mul_f32 v178, v178, v173
    v_accvgpr_write_b32 a41, v178
    v_accvgpr_read_b32 v178, a42
    v_mul_f32 v178, v178, v173
    v_accvgpr_write_b32 a42, v178
    v_accvgpr_read_b32 v178, a43
    v_mul_f32 v178, v178, v173
    v_accvgpr_write_b32 a43, v178
    v_accvgpr_read_b32 v178, a44
    v_mul_f32 v178, v178, v173
    v_accvgpr_write_b32 a44, v178
    v_accvgpr_read_b32 v178, a45
    v_mul_f32 v178, v178, v173
    v_accvgpr_write_b32 a45, v178
    v_accvgpr_read_b32 v178, a46
    v_mul_f32 v178, v178, v173
    v_accvgpr_write_b32 a46, v178
    v_accvgpr_read_b32 v178, a47
    v_mul_f32 v178, v178, v173
    v_accvgpr_write_b32 a47, v178
    v_accvgpr_read_b32 v178, a48
    v_mul_f32 v178, v178, v173
    v_accvgpr_write_b32 a48, v178
    v_accvgpr_read_b32 v178, a49
    v_mul_f32 v178, v178, v173
    v_accvgpr_write_b32 a49, v178
    v_accvgpr_read_b32 v178, a50
    v_mul_f32 v178, v178, v173
    v_accvgpr_write_b32 a50, v178
    v_accvgpr_read_b32 v178, a51
    v_mul_f32 v178, v178, v173
    v_accvgpr_write_b32 a51, v178
    v_accvgpr_read_b32 v178, a52
    v_mul_f32 v178, v178, v173
    v_accvgpr_write_b32 a52, v178
    v_accvgpr_read_b32 v178, a53
    v_mul_f32 v178, v178, v173
    v_accvgpr_write_b32 a53, v178
    v_accvgpr_read_b32 v178, a54
    v_mul_f32 v178, v178, v173
    v_accvgpr_write_b32 a54, v178
    v_accvgpr_read_b32 v178, a55
    v_mul_f32 v178, v178, v173
    v_accvgpr_write_b32 a55, v178
    v_accvgpr_read_b32 v178, a56
    v_mul_f32 v178, v178, v173
    v_accvgpr_write_b32 a56, v178
    v_accvgpr_read_b32 v178, a57
    v_mul_f32 v178, v178, v173
    v_accvgpr_write_b32 a57, v178
    v_accvgpr_read_b32 v178, a58
    v_mul_f32 v178, v178, v173
    v_accvgpr_write_b32 a58, v178
    v_accvgpr_read_b32 v178, a59
    v_mul_f32 v178, v178, v173
    v_accvgpr_write_b32 a59, v178
    v_accvgpr_read_b32 v178, a60
    v_mul_f32 v178, v178, v173
    v_accvgpr_write_b32 a60, v178
    v_accvgpr_read_b32 v178, a61
    v_mul_f32 v178, v178, v173
    v_accvgpr_write_b32 a61, v178
    v_accvgpr_read_b32 v178, a62
    v_mul_f32 v178, v178, v173
    v_accvgpr_write_b32 a62, v178
    v_accvgpr_read_b32 v178, a63
    v_mul_f32 v178, v178, v173
    v_accvgpr_write_b32 a63, v178
    v_accvgpr_read_b32 v178, a228
    v_mul_f32 v178, v178, v173
    v_accvgpr_write_b32 a228, v178
    v_accvgpr_read_b32 v178, a229
    v_mul_f32 v178, v178, v173
    v_accvgpr_write_b32 a229, v178
    v_accvgpr_read_b32 v178, a230
    v_mul_f32 v178, v178, v173
    v_accvgpr_write_b32 a230, v178
    v_accvgpr_read_b32 v178, a231
    v_mul_f32 v178, v178, v173
    v_accvgpr_write_b32 a231, v178
    v_sub_f32 v175, v184, v174
    v_exp_f32 v175, v175
    v_mov_b32 v184, v174
    v_accvgpr_read_b32 v178, a64
    v_mul_f32 v178, v178, v175
    v_accvgpr_write_b32 a64, v178
    v_accvgpr_read_b32 v178, a65
    v_mul_f32 v178, v178, v175
    v_accvgpr_write_b32 a65, v178
    v_accvgpr_read_b32 v178, a66
    v_mul_f32 v178, v178, v175
    v_accvgpr_write_b32 a66, v178
    v_accvgpr_read_b32 v178, a67
    v_mul_f32 v178, v178, v175
    v_accvgpr_write_b32 a67, v178
    v_accvgpr_read_b32 v178, a68
    v_mul_f32 v178, v178, v175
    v_accvgpr_write_b32 a68, v178
    v_accvgpr_read_b32 v178, a69
    v_mul_f32 v178, v178, v175
    v_accvgpr_write_b32 a69, v178
    v_accvgpr_read_b32 v178, a70
    v_mul_f32 v178, v178, v175
    v_accvgpr_write_b32 a70, v178
    v_accvgpr_read_b32 v178, a71
    v_mul_f32 v178, v178, v175
    v_accvgpr_write_b32 a71, v178
    v_accvgpr_read_b32 v178, a72
    v_mul_f32 v178, v178, v175
    v_accvgpr_write_b32 a72, v178
    v_accvgpr_read_b32 v178, a73
    v_mul_f32 v178, v178, v175
    v_accvgpr_write_b32 a73, v178
    v_accvgpr_read_b32 v178, a74
    v_mul_f32 v178, v178, v175
    v_accvgpr_write_b32 a74, v178
    v_accvgpr_read_b32 v178, a75
    v_mul_f32 v178, v178, v175
    v_accvgpr_write_b32 a75, v178
    v_accvgpr_read_b32 v178, a76
    v_mul_f32 v178, v178, v175
    v_accvgpr_write_b32 a76, v178
    v_accvgpr_read_b32 v178, a77
    v_mul_f32 v178, v178, v175
    v_accvgpr_write_b32 a77, v178
    v_accvgpr_read_b32 v178, a78
    v_mul_f32 v178, v178, v175
    v_accvgpr_write_b32 a78, v178
    v_accvgpr_read_b32 v178, a79
    v_mul_f32 v178, v178, v175
    v_accvgpr_write_b32 a79, v178
    v_accvgpr_read_b32 v178, a80
    v_mul_f32 v178, v178, v175
    v_accvgpr_write_b32 a80, v178
    v_accvgpr_read_b32 v178, a81
    v_mul_f32 v178, v178, v175
    v_accvgpr_write_b32 a81, v178
    v_accvgpr_read_b32 v178, a82
    v_mul_f32 v178, v178, v175
    v_accvgpr_write_b32 a82, v178
    v_accvgpr_read_b32 v178, a83
    v_mul_f32 v178, v178, v175
    v_accvgpr_write_b32 a83, v178
    v_accvgpr_read_b32 v178, a84
    v_mul_f32 v178, v178, v175
    v_accvgpr_write_b32 a84, v178
    v_accvgpr_read_b32 v178, a85
    v_mul_f32 v178, v178, v175
    v_accvgpr_write_b32 a85, v178
    v_accvgpr_read_b32 v178, a86
    v_mul_f32 v178, v178, v175
    v_accvgpr_write_b32 a86, v178
    v_accvgpr_read_b32 v178, a87
    v_mul_f32 v178, v178, v175
    v_accvgpr_write_b32 a87, v178
    v_accvgpr_read_b32 v178, a88
    v_mul_f32 v178, v178, v175
    v_accvgpr_write_b32 a88, v178
    v_accvgpr_read_b32 v178, a89
    v_mul_f32 v178, v178, v175
    v_accvgpr_write_b32 a89, v178
    v_accvgpr_read_b32 v178, a90
    v_mul_f32 v178, v178, v175
    v_accvgpr_write_b32 a90, v178
    v_accvgpr_read_b32 v178, a91
    v_mul_f32 v178, v178, v175
    v_accvgpr_write_b32 a91, v178
    v_accvgpr_read_b32 v178, a92
    v_mul_f32 v178, v178, v175
    v_accvgpr_write_b32 a92, v178
    v_accvgpr_read_b32 v178, a93
    v_mul_f32 v178, v178, v175
    v_accvgpr_write_b32 a93, v178
    v_accvgpr_read_b32 v178, a94
    v_mul_f32 v178, v178, v175
    v_accvgpr_write_b32 a94, v178
    v_accvgpr_read_b32 v178, a95
    v_mul_f32 v178, v178, v175
    v_accvgpr_write_b32 a95, v178
    v_accvgpr_read_b32 v178, a232
    v_mul_f32 v178, v178, v175
    v_accvgpr_write_b32 a232, v178
    v_accvgpr_read_b32 v178, a233
    v_mul_f32 v178, v178, v175
    v_accvgpr_write_b32 a233, v178
    v_accvgpr_read_b32 v178, a234
    v_mul_f32 v178, v178, v175
    v_accvgpr_write_b32 a234, v178
    v_accvgpr_read_b32 v178, a235
    v_mul_f32 v178, v178, v175
    v_accvgpr_write_b32 a235, v178
    v_sub_f32 v177, v185, v176
    v_exp_f32 v177, v177
    v_mov_b32 v185, v176
    v_accvgpr_read_b32 v178, a96
    v_mul_f32 v178, v178, v177
    v_accvgpr_write_b32 a96, v178
    v_accvgpr_read_b32 v178, a97
    v_mul_f32 v178, v178, v177
    v_accvgpr_write_b32 a97, v178
    v_accvgpr_read_b32 v178, a98
    v_mul_f32 v178, v178, v177
    v_accvgpr_write_b32 a98, v178
    v_accvgpr_read_b32 v178, a99
    v_mul_f32 v178, v178, v177
    v_accvgpr_write_b32 a99, v178
    v_accvgpr_read_b32 v178, a100
    v_mul_f32 v178, v178, v177
    v_accvgpr_write_b32 a100, v178
    v_accvgpr_read_b32 v178, a101
    v_mul_f32 v178, v178, v177
    v_accvgpr_write_b32 a101, v178
    v_accvgpr_read_b32 v178, a102
    v_mul_f32 v178, v178, v177
    v_accvgpr_write_b32 a102, v178
    v_accvgpr_read_b32 v178, a103
    v_mul_f32 v178, v178, v177
    v_accvgpr_write_b32 a103, v178
    v_accvgpr_read_b32 v178, a104
    v_mul_f32 v178, v178, v177
    v_accvgpr_write_b32 a104, v178
    v_accvgpr_read_b32 v178, a105
    v_mul_f32 v178, v178, v177
    v_accvgpr_write_b32 a105, v178
    v_accvgpr_read_b32 v178, a106
    v_mul_f32 v178, v178, v177
    v_accvgpr_write_b32 a106, v178
    v_accvgpr_read_b32 v178, a107
    v_mul_f32 v178, v178, v177
    v_accvgpr_write_b32 a107, v178
    v_accvgpr_read_b32 v178, a108
    v_mul_f32 v178, v178, v177
    v_accvgpr_write_b32 a108, v178
    v_accvgpr_read_b32 v178, a109
    v_mul_f32 v178, v178, v177
    v_accvgpr_write_b32 a109, v178
    v_accvgpr_read_b32 v178, a110
    v_mul_f32 v178, v178, v177
    v_accvgpr_write_b32 a110, v178
    v_accvgpr_read_b32 v178, a111
    v_mul_f32 v178, v178, v177
    v_accvgpr_write_b32 a111, v178
    v_accvgpr_read_b32 v178, a112
    v_mul_f32 v178, v178, v177
    v_accvgpr_write_b32 a112, v178
    v_accvgpr_read_b32 v178, a113
    v_mul_f32 v178, v178, v177
    v_accvgpr_write_b32 a113, v178
    v_accvgpr_read_b32 v178, a114
    v_mul_f32 v178, v178, v177
    v_accvgpr_write_b32 a114, v178
    v_accvgpr_read_b32 v178, a115
    v_mul_f32 v178, v178, v177
    v_accvgpr_write_b32 a115, v178
    v_accvgpr_read_b32 v178, a116
    v_mul_f32 v178, v178, v177
    v_accvgpr_write_b32 a116, v178
    v_accvgpr_read_b32 v178, a117
    v_mul_f32 v178, v178, v177
    v_accvgpr_write_b32 a117, v178
    v_accvgpr_read_b32 v178, a118
    v_mul_f32 v178, v178, v177
    v_accvgpr_write_b32 a118, v178
    v_accvgpr_read_b32 v178, a119
    v_mul_f32 v178, v178, v177
    v_accvgpr_write_b32 a119, v178
    v_accvgpr_read_b32 v178, a120
    v_mul_f32 v178, v178, v177
    v_accvgpr_write_b32 a120, v178
    v_accvgpr_read_b32 v178, a121
    v_mul_f32 v178, v178, v177
    v_accvgpr_write_b32 a121, v178
    v_accvgpr_read_b32 v178, a122
    v_mul_f32 v178, v178, v177
    v_accvgpr_write_b32 a122, v178
    v_accvgpr_read_b32 v178, a123
    v_mul_f32 v178, v178, v177
    v_accvgpr_write_b32 a123, v178
    v_accvgpr_read_b32 v178, a124
    v_mul_f32 v178, v178, v177
    v_accvgpr_write_b32 a124, v178
    v_accvgpr_read_b32 v178, a125
    v_mul_f32 v178, v178, v177
    v_accvgpr_write_b32 a125, v178
    v_accvgpr_read_b32 v178, a126
    v_mul_f32 v178, v178, v177
    v_accvgpr_write_b32 a126, v178
    v_accvgpr_read_b32 v178, a127
    v_mul_f32 v178, v178, v177
    v_accvgpr_write_b32 a127, v178
    v_accvgpr_read_b32 v178, a236
    v_mul_f32 v178, v178, v177
    v_accvgpr_write_b32 a236, v178
    v_accvgpr_read_b32 v178, a237
    v_mul_f32 v178, v178, v177
    v_accvgpr_write_b32 a237, v178
    v_accvgpr_read_b32 v178, a238
    v_mul_f32 v178, v178, v177
    v_accvgpr_write_b32 a238, v178
    v_accvgpr_read_b32 v178, a239
    v_mul_f32 v178, v178, v177
    v_accvgpr_write_b32 a239, v178
    v_sub_f32 v0, v0, v170
    v_sub_f32 v1, v1, v170
    v_sub_f32 v2, v2, v170
    v_sub_f32 v3, v3, v170
    v_sub_f32 v4, v4, v172
    v_sub_f32 v5, v5, v172
    v_sub_f32 v6, v6, v172
    v_sub_f32 v7, v7, v172
    v_sub_f32 v8, v8, v174
    v_sub_f32 v9, v9, v174
    v_sub_f32 v10, v10, v174
    v_sub_f32 v11, v11, v174
    v_sub_f32 v12, v12, v176
    v_sub_f32 v13, v13, v176
    v_sub_f32 v14, v14, v176
    v_sub_f32 v15, v15, v176
    v_sub_f32 v16, v16, v170
    v_sub_f32 v17, v17, v170
    v_sub_f32 v18, v18, v170
    v_sub_f32 v19, v19, v170
    v_sub_f32 v20, v20, v172
    v_sub_f32 v21, v21, v172
    v_sub_f32 v22, v22, v172
    v_sub_f32 v23, v23, v172
    v_sub_f32 v24, v24, v174
    v_sub_f32 v25, v25, v174
    v_sub_f32 v26, v26, v174
    v_sub_f32 v27, v27, v174
    v_sub_f32 v28, v28, v176
    v_sub_f32 v29, v29, v176
    v_sub_f32 v30, v30, v176
    v_sub_f32 v31, v31, v176
    v_sub_f32 v32, v32, v170
    v_sub_f32 v33, v33, v170
    v_sub_f32 v34, v34, v170
    v_sub_f32 v35, v35, v170
    v_sub_f32 v36, v36, v172
    v_sub_f32 v37, v37, v172
    v_sub_f32 v38, v38, v172
    v_sub_f32 v39, v39, v172
    v_sub_f32 v40, v40, v174
    v_sub_f32 v41, v41, v174
    v_sub_f32 v42, v42, v174
    v_sub_f32 v43, v43, v174
    v_sub_f32 v44, v44, v176
    v_sub_f32 v45, v45, v176
    v_sub_f32 v46, v46, v176
    v_sub_f32 v47, v47, v176
    v_sub_f32 v48, v48, v170
    v_sub_f32 v49, v49, v170
    v_sub_f32 v50, v50, v170
    v_sub_f32 v51, v51, v170
    v_sub_f32 v52, v52, v172
    v_sub_f32 v53, v53, v172
    v_sub_f32 v54, v54, v172
    v_sub_f32 v55, v55, v172
    v_sub_f32 v56, v56, v174
    v_sub_f32 v57, v57, v174
    v_sub_f32 v58, v58, v174
    v_sub_f32 v59, v59, v174
    v_sub_f32 v60, v60, v176
    v_sub_f32 v61, v61, v176
    v_sub_f32 v62, v62, v176
    v_sub_f32 v63, v63, v176
    v_exp_f32 v0, v0
    v_exp_f32 v1, v1
    v_exp_f32 v2, v2
    v_exp_f32 v3, v3
    v_exp_f32 v4, v4
    v_exp_f32 v5, v5
    v_exp_f32 v6, v6
    v_exp_f32 v7, v7
    v_exp_f32 v8, v8
    v_exp_f32 v9, v9
    v_exp_f32 v10, v10
    v_exp_f32 v11, v11
    v_exp_f32 v12, v12
    v_exp_f32 v13, v13
    v_exp_f32 v14, v14
    v_exp_f32 v15, v15
    v_exp_f32 v16, v16
    v_exp_f32 v17, v17
    v_exp_f32 v18, v18
    v_exp_f32 v19, v19
    v_exp_f32 v20, v20
    v_exp_f32 v21, v21
    v_exp_f32 v22, v22
    v_exp_f32 v23, v23
    v_exp_f32 v24, v24
    v_exp_f32 v25, v25
    v_exp_f32 v26, v26
    v_exp_f32 v27, v27
    v_exp_f32 v28, v28
    v_exp_f32 v29, v29
    v_exp_f32 v30, v30
    v_exp_f32 v31, v31
    v_exp_f32 v32, v32
    v_exp_f32 v33, v33
    v_exp_f32 v34, v34
    v_exp_f32 v35, v35
    v_exp_f32 v36, v36
    v_exp_f32 v37, v37
    v_exp_f32 v38, v38
    v_exp_f32 v39, v39
    v_exp_f32 v40, v40
    v_exp_f32 v41, v41
    v_exp_f32 v42, v42
    v_exp_f32 v43, v43
    v_exp_f32 v44, v44
    v_exp_f32 v45, v45
    v_exp_f32 v46, v46
    v_exp_f32 v47, v47
    v_exp_f32 v48, v48
    v_exp_f32 v49, v49
    v_exp_f32 v50, v50
    v_exp_f32 v51, v51
    v_exp_f32 v52, v52
    v_exp_f32 v53, v53
    v_exp_f32 v54, v54
    v_exp_f32 v55, v55
    v_exp_f32 v56, v56
    v_exp_f32 v57, v57
    v_exp_f32 v58, v58
    v_exp_f32 v59, v59
    v_exp_f32 v60, v60
    v_exp_f32 v61, v61
    v_exp_f32 v62, v62
    v_exp_f32 v63, v63
    s_nop 0
    v_cvt_pk_bf16_f32 v96, v0, v1
    v_cvt_pk_bf16_f32 v97, v2, v3
    v_cvt_pk_bf16_f32 v100, v4, v5
    v_cvt_pk_bf16_f32 v101, v6, v7
    v_cvt_pk_bf16_f32 v104, v8, v9
    v_cvt_pk_bf16_f32 v105, v10, v11
    v_cvt_pk_bf16_f32 v108, v12, v13
    v_cvt_pk_bf16_f32 v109, v14, v15
    v_cvt_pk_bf16_f32 v98, v16, v17
    v_cvt_pk_bf16_f32 v99, v18, v19
    v_cvt_pk_bf16_f32 v102, v20, v21
    v_cvt_pk_bf16_f32 v103, v22, v23
    v_cvt_pk_bf16_f32 v106, v24, v25
    v_cvt_pk_bf16_f32 v107, v26, v27
    v_cvt_pk_bf16_f32 v110, v28, v29
    v_cvt_pk_bf16_f32 v111, v30, v31
    v_cvt_pk_bf16_f32 v112, v32, v33
    v_cvt_pk_bf16_f32 v113, v34, v35
    v_cvt_pk_bf16_f32 v116, v36, v37
    v_cvt_pk_bf16_f32 v117, v38, v39
    v_cvt_pk_bf16_f32 v120, v40, v41
    v_cvt_pk_bf16_f32 v121, v42, v43
    v_cvt_pk_bf16_f32 v124, v44, v45
    v_cvt_pk_bf16_f32 v125, v46, v47
    v_cvt_pk_bf16_f32 v114, v48, v49
    v_cvt_pk_bf16_f32 v115, v50, v51
    v_cvt_pk_bf16_f32 v118, v52, v53
    v_cvt_pk_bf16_f32 v119, v54, v55
    v_cvt_pk_bf16_f32 v122, v56, v57
    v_cvt_pk_bf16_f32 v123, v58, v59
    v_cvt_pk_bf16_f32 v126, v60, v61
    v_cvt_pk_bf16_f32 v127, v62, v63
    s_nop 1
    v_mfma_f32_16x16x32_bf16 a[224:227], a[240:243], v[96:99], a[224:227]
    v_mfma_f32_16x16x32_bf16 a[224:227], a[240:243], v[112:115], a[224:227]
    v_mfma_f32_16x16x32_bf16 a[228:231], a[240:243], v[100:103], a[228:231]
    v_mfma_f32_16x16x32_bf16 a[228:231], a[240:243], v[116:119], a[228:231]
    v_mfma_f32_16x16x32_bf16 a[232:235], a[240:243], v[104:107], a[232:235]
    v_mfma_f32_16x16x32_bf16 a[232:235], a[240:243], v[120:123], a[232:235]
    v_mfma_f32_16x16x32_bf16 a[236:239], a[240:243], v[108:111], a[236:239]
    v_mfma_f32_16x16x32_bf16 a[236:239], a[240:243], v[124:127], a[236:239]
    s_add_u32 s17, s39, 0xa000
    s_and_b32 s17, s17, 0xfffff
    s_add_u32 s17, s17, s22
    buffer_load_dwordx4 a[192:195], v164, s[4:7], s17 offen offset:0 sc1
    buffer_load_dwordx4 a[196:199], v164, s[4:7], s17 offen offset:1024 sc1
    buffer_load_dwordx4 a[200:203], v164, s[4:7], s17 offen offset:2048 sc1
    buffer_load_dwordx4 a[204:207], v164, s[4:7], s17 offen offset:3072 sc1
    s_add_u32 s17, s17, 0x1000
    buffer_load_dwordx4 a[208:211], v164, s[4:7], s17 offen offset:0 sc1
    buffer_load_dwordx4 a[212:215], v164, s[4:7], s17 offen offset:1024 sc1
    buffer_load_dwordx4 a[216:219], v164, s[4:7], s17 offen offset:2048 sc1
    buffer_load_dwordx4 a[220:223], v164, s[4:7], s17 offen offset:3072 sc1
    s_add_u32 s17, s17, 0x1000
    s_waitcnt vmcnt(0)
    v_mfma_f32_16x16x32_bf16 a[0:3], a[192:195], v[96:99], a[0:3]
    v_mfma_f32_16x16x32_bf16 a[32:35], a[192:195], v[100:103], a[32:35]
    v_mfma_f32_16x16x32_bf16 a[64:67], a[192:195], v[104:107], a[64:67]
    v_mfma_f32_16x16x32_bf16 a[96:99], a[192:195], v[108:111], a[96:99]
    v_mfma_f32_16x16x32_bf16 a[0:3], a[196:199], v[112:115], a[0:3]
    v_mfma_f32_16x16x32_bf16 a[32:35], a[196:199], v[116:119], a[32:35]
    v_mfma_f32_16x16x32_bf16 a[64:67], a[196:199], v[120:123], a[64:67]
    v_mfma_f32_16x16x32_bf16 a[96:99], a[196:199], v[124:127], a[96:99]
    v_mfma_f32_16x16x32_bf16 a[4:7], a[200:203], v[96:99], a[4:7]
    v_mfma_f32_16x16x32_bf16 a[36:39], a[200:203], v[100:103], a[36:39]
    v_mfma_f32_16x16x32_bf16 a[68:71], a[200:203], v[104:107], a[68:71]
    v_mfma_f32_16x16x32_bf16 a[100:103], a[200:203], v[108:111], a[100:103]
    v_mfma_f32_16x16x32_bf16 a[4:7], a[204:207], v[112:115], a[4:7]
    v_mfma_f32_16x16x32_bf16 a[36:39], a[204:207], v[116:119], a[36:39]
    v_mfma_f32_16x16x32_bf16 a[68:71], a[204:207], v[120:123], a[68:71]
    v_mfma_f32_16x16x32_bf16 a[100:103], a[204:207], v[124:127], a[100:103]
    v_mfma_f32_16x16x32_bf16 a[8:11], a[208:211], v[96:99], a[8:11]
    v_mfma_f32_16x16x32_bf16 a[40:43], a[208:211], v[100:103], a[40:43]
    v_mfma_f32_16x16x32_bf16 a[72:75], a[208:211], v[104:107], a[72:75]
    v_mfma_f32_16x16x32_bf16 a[104:107], a[208:211], v[108:111], a[104:107]
    v_mfma_f32_16x16x32_bf16 a[8:11], a[212:215], v[112:115], a[8:11]
    v_mfma_f32_16x16x32_bf16 a[40:43], a[212:215], v[116:119], a[40:43]
    v_mfma_f32_16x16x32_bf16 a[72:75], a[212:215], v[120:123], a[72:75]
    v_mfma_f32_16x16x32_bf16 a[104:107], a[212:215], v[124:127], a[104:107]
    v_mfma_f32_16x16x32_bf16 a[12:15], a[216:219], v[96:99], a[12:15]
    v_mfma_f32_16x16x32_bf16 a[44:47], a[216:219], v[100:103], a[44:47]
    v_mfma_f32_16x16x32_bf16 a[76:79], a[216:219], v[104:107], a[76:79]
    v_mfma_f32_16x16x32_bf16 a[108:111], a[216:219], v[108:111], a[108:111]
    v_mfma_f32_16x16x32_bf16 a[12:15], a[220:223], v[112:115], a[12:15]
    v_mfma_f32_16x16x32_bf16 a[44:47], a[220:223], v[116:119], a[44:47]
    v_mfma_f32_16x16x32_bf16 a[76:79], a[220:223], v[120:123], a[76:79]
    v_mfma_f32_16x16x32_bf16 a[108:111], a[220:223], v[124:127], a[108:111]
    s_nop 15
    s_add_u32 s17, s39, 0xc000
    s_and_b32 s17, s17, 0xfffff
    s_add_u32 s17, s17, s22
    buffer_load_dwordx4 a[192:195], v164, s[4:7], s17 offen offset:0 sc1
    buffer_load_dwordx4 a[196:199], v164, s[4:7], s17 offen offset:1024 sc1
    buffer_load_dwordx4 a[200:203], v164, s[4:7], s17 offen offset:2048 sc1
    buffer_load_dwordx4 a[204:207], v164, s[4:7], s17 offen offset:3072 sc1
    s_add_u32 s17, s17, 0x1000
    buffer_load_dwordx4 a[208:211], v164, s[4:7], s17 offen offset:0 sc1
    buffer_load_dwordx4 a[212:215], v164, s[4:7], s17 offen offset:1024 sc1
    buffer_load_dwordx4 a[216:219], v164, s[4:7], s17 offen offset:2048 sc1
    buffer_load_dwordx4 a[220:223], v164, s[4:7], s17 offen offset:3072 sc1
    s_add_u32 s17, s17, 0x1000
    s_waitcnt vmcnt(0)
    v_mfma_f32_16x16x32_bf16 a[16:19], a[192:195], v[96:99], a[16:19]
    v_mfma_f32_16x16x32_bf16 a[48:51], a[192:195], v[100:103], a[48:51]
    v_mfma_f32_16x16x32_bf16 a[80:83], a[192:195], v[104:107], a[80:83]
    v_mfma_f32_16x16x32_bf16 a[112:115], a[192:195], v[108:111], a[112:115]
    v_mfma_f32_16x16x32_bf16 a[16:19], a[196:199], v[112:115], a[16:19]
    v_mfma_f32_16x16x32_bf16 a[48:51], a[196:199], v[116:119], a[48:51]
    v_mfma_f32_16x16x32_bf16 a[80:83], a[196:199], v[120:123], a[80:83]
    v_mfma_f32_16x16x32_bf16 a[112:115], a[196:199], v[124:127], a[112:115]
    v_mfma_f32_16x16x32_bf16 a[20:23], a[200:203], v[96:99], a[20:23]
    v_mfma_f32_16x16x32_bf16 a[52:55], a[200:203], v[100:103], a[52:55]
    v_mfma_f32_16x16x32_bf16 a[84:87], a[200:203], v[104:107], a[84:87]
    v_mfma_f32_16x16x32_bf16 a[116:119], a[200:203], v[108:111], a[116:119]
    v_mfma_f32_16x16x32_bf16 a[20:23], a[204:207], v[112:115], a[20:23]
    v_mfma_f32_16x16x32_bf16 a[52:55], a[204:207], v[116:119], a[52:55]
    v_mfma_f32_16x16x32_bf16 a[84:87], a[204:207], v[120:123], a[84:87]
    v_mfma_f32_16x16x32_bf16 a[116:119], a[204:207], v[124:127], a[116:119]
    v_mfma_f32_16x16x32_bf16 a[24:27], a[208:211], v[96:99], a[24:27]
    v_mfma_f32_16x16x32_bf16 a[56:59], a[208:211], v[100:103], a[56:59]
    v_mfma_f32_16x16x32_bf16 a[88:91], a[208:211], v[104:107], a[88:91]
    v_mfma_f32_16x16x32_bf16 a[120:123], a[208:211], v[108:111], a[120:123]
    v_mfma_f32_16x16x32_bf16 a[24:27], a[212:215], v[112:115], a[24:27]
    v_mfma_f32_16x16x32_bf16 a[56:59], a[212:215], v[116:119], a[56:59]
    v_mfma_f32_16x16x32_bf16 a[88:91], a[212:215], v[120:123], a[88:91]
    v_mfma_f32_16x16x32_bf16 a[120:123], a[212:215], v[124:127], a[120:123]
    v_mfma_f32_16x16x32_bf16 a[28:31], a[216:219], v[96:99], a[28:31]
    v_mfma_f32_16x16x32_bf16 a[60:63], a[216:219], v[100:103], a[60:63]
    v_mfma_f32_16x16x32_bf16 a[92:95], a[216:219], v[104:107], a[92:95]
    v_mfma_f32_16x16x32_bf16 a[124:127], a[216:219], v[108:111], a[124:127]
    v_mfma_f32_16x16x32_bf16 a[28:31], a[220:223], v[112:115], a[28:31]
    v_mfma_f32_16x16x32_bf16 a[60:63], a[220:223], v[116:119], a[60:63]
    v_mfma_f32_16x16x32_bf16 a[92:95], a[220:223], v[120:123], a[92:95]
    v_mfma_f32_16x16x32_bf16 a[124:127], a[220:223], v[124:127], a[124:127]
    s_nop 15
    s_add_u32 s39, s39, 32768
    s_sub_u32 s16, s16, 1
    s_cmp_lg_u32 s16, 0
    s_cbranch_scc1 L_fb_loop
    s_branch L_epi
.section .rodata,"a"
.p2align 6
.amdhsa_kernel standalone__kv_cache_quant_int4_int2_kv_with_per_channel_or_per_token_scales__prompt_kernel
  .amdhsa_next_free_vgpr 512
  .amdhsa_next_free_sgpr 102
  .amdhsa_accum_offset 256
  .amdhsa_group_segment_fixed_size 0
  .amdhsa_kernarg_size 80
  .amdhsa_user_sgpr_count 2
  .amdhsa_user_sgpr_kernarg_segment_ptr 1
  .amdhsa_system_sgpr_workgroup_id_x 1
.end_amdhsa_kernel
```
